```python
import torch

def _softmax(x, axis=-1):
    return torch.softmax(x, dim=axis)
def _gelu(x):
    return torch.nn.functional.gelu(x, approximate="tanh")
def _silu(x):
    return torch.nn.functional.silu(x)
def _sigmoid(x):
    return torch.sigmoid(x)
def _layernorm(x, axis=-1, eps=1e-5):
    m = x.mean(dim=axis, keepdim=True)
    v = x.var(dim=axis, keepdim=True, unbiased=False)
    return (x - m) / torch.sqrt(v + eps)
def _scatter_add(tgt, idx, src, axis=0):
    return tgt.clone().index_add_(axis, idx, src)
def _segment_sum(src, seg, n):
    out = torch.zeros((n,) + src.shape[1:], dtype=src.dtype)
    return out.index_add_(0, seg, src)
def _pad(x, pw):
    flat = tuple(v for pair in reversed(pw) for v in pair)
    return torch.nn.functional.pad(x, flat)

kernel_name = 'gated_mix__ssm_conv_s5__grouped_kv_mqa__prompt'

def setup_inputs():

    _w = (lambda a: (lambda t: t.to(torch.bfloat16) if t.is_floating_point() else t)(torch.as_tensor(a)))
    def _A_setup():
        B, S, D = 1, 2048, 576
        P = D
        Lambda_re = -0.5 * (lambda _x: torch.exp(torch.as_tensor(_x)))((lambda *s: torch.randn(*s, dtype=torch.bfloat16) * 0.2)(P))
        Lambda_im = (lambda *s: torch.randn(*s, dtype=torch.bfloat16) * 0.4)(P) * 1.0
        B_re = (lambda *s: torch.randn(*s, dtype=torch.bfloat16) * 0.2)(P, D) * (D ** -0.5)
        B_im = (lambda *s: torch.randn(*s, dtype=torch.bfloat16) * 0.2)(P, D) * (D ** -0.5)
        C_re = (lambda *s: torch.randn(*s, dtype=torch.bfloat16) * 0.2)(D, P) * (P ** -0.5)
        C_im = (lambda *s: torch.randn(*s, dtype=torch.bfloat16) * 0.2)(D, P) * (P ** -0.5)
        log_dt = (lambda *s: torch.randn(*s, dtype=torch.bfloat16) * 0.2)(P) * 0.3 - 2.0
        Dskip = (lambda *s: torch.randn(*s, dtype=torch.bfloat16) * 0.05)(D)
        return {
            "x": _w((lambda *s: torch.randn(*s, dtype=torch.bfloat16) * 0.05)(B, S, D)),
            "Lambda_re": _w(Lambda_re),
            "Lambda_im": _w(Lambda_im),
            "B_re": _w(B_re),
            "B_im": _w(B_im),
            "C_re": _w(C_re),
            "C_im": _w(C_im),
            "log_dt": _w(log_dt),
            "Dskip": _w(Dskip),
        }
    _A_in = _A_setup()

    def _B_setup():
        B, S, D, H = 1, 2048, 576, 32
        Dh = D // H
        return {
            "x": _w((lambda *s: torch.randn(*s, dtype=torch.bfloat16) * 0.05)(B, S, D)),
            "wq": _w((lambda *s: torch.randn(*s, dtype=torch.bfloat16) * 0.8)(D, H * Dh)),
            "wk": _w((lambda *s: torch.randn(*s, dtype=torch.bfloat16) * 0.8)(D, Dh)),
            "wv": _w((lambda *s: torch.randn(*s, dtype=torch.bfloat16) * 0.05)(D, Dh)),
            "wo": _w((lambda *s: torch.randn(*s, dtype=torch.bfloat16) * 0.05)(H * Dh, D)),
        }
    _B_in = _B_setup()

    return {
        "A_x": _A_in["x"],
        "A_Lambda_re": _A_in["Lambda_re"],
        "A_Lambda_im": _A_in["Lambda_im"],
        "A_B_re": _A_in["B_re"],
        "A_B_im": _A_in["B_im"],
        "A_C_re": _A_in["C_re"],
        "A_C_im": _A_in["C_im"],
        "A_log_dt": _A_in["log_dt"],
        "A_Dskip": _A_in["Dskip"],
        "B_x": _B_in["x"],
        "B_wq": _B_in["wq"],
        "B_wk": _B_in["wk"],
        "B_wv": _B_in["wv"],
        "B_wo": _B_in["wo"],
        "gate_w": _w((lambda *s: torch.randn(*s, dtype=torch.bfloat16) * 0.05)(576) * 16.0),
    }

def reference(A_x, A_Lambda_re, A_Lambda_im, A_B_re, A_B_im, A_C_re, A_C_im, A_log_dt, A_Dskip, B_x, B_wq, B_wk, B_wv, B_wo, gate_w):
    def _A_ref(x, Lambda_re, Lambda_im, B_re, B_im, C_re, C_im, log_dt, Dskip):
        Bsz, L, H = x.shape
        Lam = Lambda_re + 1j * Lambda_im
        Bmat = B_re + 1j * B_im
        Cmat = C_re + 1j * C_im
        dt = torch.exp(log_dt)
        Lam_bar = torch.exp(dt * Lam)
        B_bar = ((Lam_bar - 1.0) / Lam)[:, None] * Bmat
        Bu = torch.einsum("bld,pd->blp", x + 0j, B_bar)
        h = torch.zeros_like(Bu[:, 0, :])
        hs = []
        for t in range(L):
            h = Lam_bar[None, :] * h + Bu[:, t, :]
            hs.append(h)
        hseq = torch.stack(hs, 1)
        y = 2.0 * torch.einsum("blp,dp->bld", hseq, Cmat).real + x * Dskip[None, None, :]
        return y

    def _B_ref(x, wq, wk, wv, wo):
        B, S, D = x.shape
        H = 32
        Dh = D // H
        q = (lambda x, *d: x.permute(*d))((x @ wq).reshape(B, S, H, Dh), 0, 2, 1, 3)
        k = x @ wk
        v = x @ wv
        scores = torch.einsum("bhqd,bkd->bhqk", q, k) * (Dh ** -0.5)
        p = _softmax(scores, axis=-1)
        o = torch.einsum("bhqk,bkd->bhqd", p, v)
        return (lambda x, *d: x.permute(*d))(o, 0, 2, 1, 3).reshape(B, S, H * Dh) @ wo

    x = A_x
    g = _sigmoid((x * gate_w).sum(-1, keepdims=True))
    a = _A_ref(x, A_Lambda_re, A_Lambda_im, A_B_re, A_B_im, A_C_re, A_C_im, A_log_dt, A_Dskip)
    b = _B_ref(x, B_wq, B_wk, B_wv, B_wo)
    return g * a + (1 - g) * b
```

```asm
; @launch grid=(256,1,1) block=(768,1,1) lds=163840
.amdgcn_target "amdgcn-amd-amdhsa--gfx950"
.text
.globl gated_mix__ssm_conv_s5__grouped_kv_mqa__prompt_kernel
.p2align 8
.type gated_mix__ssm_conv_s5__grouped_kv_mqa__prompt_kernel,@function
gated_mix__ssm_conv_s5__grouped_kv_mqa__prompt_kernel:
    s_cmp_ge_u32 s2, 256
    s_cbranch_scc1 L_end
    s_load_dwordx16 s[16:31], s[0:1], 0
    s_load_dwordx16 s[32:47], s[0:1], 64
    s_load_dwordx4 s[48:51], s[0:1], 128
    v_readfirstlane_b32 s5, v0
    v_and_b32 v0, 63, v0
    s_and_b32 s3, s2, 7
    s_lshr_b32 s7, s2, 3
    s_lshl_b32 s3, s3, 2
    s_and_b32 s8, s7, 3
    s_add_u32 s3, s3, s8
    s_lshr_b32 s4, s7, 2
    s_lshr_b32 s5, s5, 6
    s_cmp_lt_u32 s5, 8
    s_cbranch_scc1 L_att
    s_setprio 3
    s_sub_u32 s80, s5, 8
    s_lshr_b32 s81, s80, 1
    s_and_b32 s82, s80, 1
    v_lshrrev_b32 v1, 3, v0
    v_and_b32 v2, 7, v0
    v_lshrrev_b32 v3, 4, v0
    v_xor_b32 v2, v2, v3
    v_lshlrev_b32 v2, 4, v2
    v_mul_u32_u24 v12, 1152, v1
    v_add_u32 v12, v12, v2
    v_xor_b32 v13, 64, v12
    v_lshrrev_b32 v159, 2, v1
    v_and_b32 v3, 3, v1
    v_lshl_add_u32 v159, v159, 5, v3
    s_add_u32 s8, s3, s4
    s_mul_i32 s9, s8, 43
    s_lshr_b32 s9, s9, 7
    s_mul_i32 s9, s9, 3
    s_sub_u32 s8, s8, s9
    s_mul_i32 s84, s8, 384
    s_add_u32 s8, s8, 1
    s_cmp_eq_u32 s8, 3
    s_cselect_b32 s8, 0, s8
    s_mul_i32 s85, s8, 384
    s_add_u32 s8, s8, 1
    s_cmp_eq_u32 s8, 3
    s_cselect_b32 s8, 0, s8
    s_mul_i32 s86, s8, 384
    v_mul_u32_u24 v159, 1152, v159
    v_add_u32 v159, v159, v2
    s_lshl_b32 s8, s82, 6
    v_xor_b32 v160, s8, v159
    v_mul_u32_u24 v1, 43, v0
    v_lshrrev_b32 v1, 7, v1
    v_mul_u32_u24 v2, 12, v1
    v_lshlrev_b32 v161, 4, v0
    v_sub_u32 v162, v161, v2
    s_and_b32 s8, s4, 3
    s_mul_i32 s9, s3, 73728
    s_lshl_b32 s10, s8, 1
    s_add_u32 s10, s10, s82
    s_mul_i32 s11, s10, 4608
    s_add_u32 s11, s11, s9
    s_lshl_b32 s10, s10, 10
    s_lshl_b32 s12, s81, 8
    s_add_u32 s12, s12, s11
    s_lshl_b32 s13, s81, 14
    s_add_u32 s13, s13, s10
    s_add_u32 s11, s11, 128
    s_cmp_eq_u32 s81, 0
    s_cselect_b32 s8, s84, s86
    s_mul_i32 s9, s81, 49152
    s_add_u32 s9, s9, s10
    s_mul_i32 s92, s4, 144
    s_lshl_b32 s93, s80, 5
    s_add_u32 s93, s93, s92
    s_lshl_b32 s94, s80, 2
    s_add_u32 s92, s92, s94
    s_add_u32 s92, s92, 128
    v_and_b32 v4, 30, v0
    v_add_u32 v4, s93, v4
    v_and_b32 v5, 2, v0
    v_add_u32 v5, s92, v5
    s_waitcnt lgkmcnt(0)
    s_load_dword s6, s[50:51], 0
    s_mov_b32 s52, s50
    s_mov_b32 s53, s51
    s_mov_b32 s54, 8388608
    s_mov_b32 s55, 0x20000
    s_mov_b32 s56, s16
    s_mov_b32 s57, s17
    s_mov_b32 s58, 2359296
    s_mov_b32 s59, 0x20000
    s_add_u32 m0, s13, 0
    s_add_u32 s14, s12, s84
    buffer_load_dwordx4 v160, s[56:59], s14 offen lds
    s_add_u32 m0, s13, 24576
    s_add_u32 s14, s12, s85
    buffer_load_dwordx4 v160, s[56:59], s14 offen lds
    s_add_u32 m0, s13, 49152
    s_add_u32 s14, s12, s86
    buffer_load_dwordx4 v160, s[56:59], s14 offen lds
    s_add_u32 m0, s9, 8192
    s_add_u32 s14, s11, s8
    buffer_load_dwordx4 v160, s[56:59], s14 offen lds
    s_add_u32 m0, s10, 32768
    s_add_u32 s14, s11, s85
    buffer_load_dwordx4 v160, s[56:59], s14 offen lds
    s_cmp_lt_u32 s4, 4
    s_cselect_b32 s64, s38, s40
    s_cselect_b32 s65, s39, s41
    s_mov_b32 s66, 20736
    s_mov_b32 s67, 0x20000
    s_mul_i32 s12, s80, 5292
    s_mul_i32 s13, s80, 7056
    s_add_u32 m0, s13, 73728
    s_add_u32 s14, s12, 0
    buffer_load_dwordx4 v162, s[64:67], s14 offen lds
    s_add_u32 m0, s13, 74736
    s_add_u32 s14, s12, 756
    buffer_load_dwordx4 v162, s[64:67], s14 offen lds
    s_add_u32 m0, s13, 75744
    s_add_u32 s14, s12, 1512
    buffer_load_dwordx4 v162, s[64:67], s14 offen lds
    s_add_u32 m0, s13, 76752
    s_add_u32 s14, s12, 2268
    buffer_load_dwordx4 v162, s[64:67], s14 offen lds
    s_add_u32 m0, s13, 77760
    s_add_u32 s14, s12, 3024
    buffer_load_dwordx4 v162, s[64:67], s14 offen lds
    s_add_u32 m0, s13, 78768
    s_add_u32 s14, s12, 3780
    buffer_load_dwordx4 v162, s[64:67], s14 offen lds
    s_add_u32 m0, s13, 79776
    s_add_u32 s14, s12, 4536
    buffer_load_dwordx4 v162, s[64:67], s14 offen lds
    global_load_ushort v48, v4, s[18:19]
    global_load_ushort v52, v5, s[18:19]
    global_load_ushort v49, v4, s[20:21]
    global_load_ushort v53, v5, s[20:21]
    global_load_ushort v50, v4, s[30:31]
    global_load_ushort v54, v5, s[30:31]
    s_barrier
    s_waitcnt lgkmcnt(0)
    s_mul_i32 s6, s6, 0x9E3779B1
    s_add_u32 s6, s6, 0x7F4A7C15
    s_mov_b32 s72, s22
    s_mov_b32 s73, s23
    s_mov_b32 s74, 663552
    s_mov_b32 s75, 0x20000
    s_mov_b32 s76, s24
    s_mov_b32 s77, s25
    s_mov_b32 s78, 663552
    s_mov_b32 s79, 0x20000
    v_mul_u32_u24 v1, 57, v0
    v_lshrrev_b32 v1, 9, v1
    v_mul_u32_u24 v2, 1008, v1
    v_add_u32 v14, v161, v2
    v_and_b32 v41, 31, v0
    v_lshrrev_b32 v42, 5, v0
    v_bfe_u32 v43, v0, 1, 3
    v_xor_b32 v42, v42, v43
    v_lshlrev_b32 v42, 4, v42
    v_lshl_add_u32 v4, v41, 7, v42
    v_xor_b32 v5, 32, v4
    v_xor_b32 v6, 64, v4
    v_xor_b32 v7, 96, v4
    v_and_b32 v41, 1, v0
    v_bfe_u32 v42, v0, 1, 3
    v_bfe_u32 v43, v0, 4, 1
    v_lshl_add_u32 v43, v41, 1, v43
    v_lshlrev_b32 v43, 10, v43
    v_lshl_add_u32 v43, v42, 7, v43
    v_lshrrev_b32 v42, 1, v42
    v_lshl_or_b32 v42, v41, 2, v42
    v_lshrrev_b32 v44, 5, v0
    v_and_b32 v45, 31, v0
    v_xor_b32 v42, v42, v44
    v_lshl_add_u32 v43, v42, 4, v43
    s_lshl_b32 s92, s80, 13
    s_add_u32 s92, s92, 115456
    v_add_u32 v8, s92, v43
    v_xor_b32 v9, 32, v8
    v_xor_b32 v10, 64, v8
    v_xor_b32 v11, 96, v8
    v_lshlrev_b32 v15, 2, v0
    v_lshlrev_b32 v90, 7, v0
    v_mul_u32_u24 v86, 144, v45
    v_lshl_add_u32 v86, v44, 6, v86
    s_mul_i32 s92, s80, 18432
    v_add_u32 v86, s92, v86
    v_bfe_u32 v42, v0, 2, 2
    v_mul_u32_u24 v87, 288, v42
    v_lshrrev_b32 v42, 4, v0
    v_lshl_add_u32 v87, v42, 5, v87
    v_and_b32 v46, 3, v0
    v_lshl_add_u32 v87, v46, 3, v87
    v_add_u32 v87, s92, v87
    s_mul_i32 s92, s4, 640
    s_lshl_b32 s93, s80, 7
    s_add_u32 s93, s93, s92
    v_lshl_add_u32 v43, v45, 2, s93
    v_lshl_add_u32 v84, v44, 30, v43
    v_mul_u32_u24 v42, 5120, v0
    v_add_u32 v83, s93, v42
    s_sub_u32 s93, 48, s3
    s_mul_i32 s93, s93, 5120
    v_mul_u32_u24 v42, 81920, v44
    v_sub_u32 v42, s93, v42
    v_add_u32 v85, v42, v43
    s_lshl_b32 s93, s80, 4
    s_add_u32 s93, s93, s92
    s_add_u32 s93, s93, 512
    v_lshl_add_u32 v43, v46, 2, s93
    v_lshrrev_b32 v47, 2, v0
    v_sub_u32 v42, 15, v47
    v_lshl_add_u32 v71, v42, 26, v43
    s_sub_u32 s93, 62, s3
    s_mul_i32 s93, s93, 5120
    v_mul_u32_u24 v42, 10240, v47
    v_sub_u32 v42, s93, v42
    v_add_u32 v72, v42, v43
    s_mul_i32 s93, s80, 1088
    s_add_u32 s93, s93, 157696
    v_mul_u32_u24 v42, 272, v46
    v_lshl_add_u32 v42, v47, 4, v42
    v_add_u32 v70, s93, v42
    v_mul_u32_u24 v42, 73728, v41
    v_and_b32 v43, 62, v0
    v_lshl_add_u32 v42, v43, 4, v42
    s_lshl_b32 s93, s80, 2
    v_add_u32 v73, s93, v42
    v_bfe_u32 v42, v0, 1, 1
    s_mov_b32 s93, 0x04040404
    v_mul_lo_u32 v42, v42, s93
    v_xor_b32 v68, 0x01000504, v42
    v_xor_b32 v69, 0x03020706, v42
    s_lshl_b32 s93, s80, 2
    s_add_u32 s93, s93, 162624
    v_lshl_add_u32 v88, v0, 18, s93
    v_lshlrev_b32 v89, 2, v46
    v_add_u32 v89, 162624, v89
    v_and_b32 v42, 7, v0
    v_lshlrev_b32 v95, 2, v42
    v_add_u32 v95, 162560, v95
    v_lshrrev_b32 v43, 1, v42
    v_xor_b32 v43, v43, v44
    v_lshlrev_b32 v43, 4, v43
    v_lshl_add_u32 v42, v42, 7, v43
    v_lshrrev_b32 v43, 1, v0
    v_xor_b32 v43, v43, v0
    v_bfe_u32 v43, v43, 3, 1
    v_lshl_add_u32 v42, v43, 18, v42
    s_mul_i32 s93, s80, 18432
    s_add_u32 s93, s93, 8192
    v_add_u32 v93, s93, v42
    v_lshlrev_b32 v42, 10, v44
    v_lshl_add_u32 v94, v45, 4, v42
    v_lshlrev_b32 v163, 3, v0
    v_mov_b32 v56, 1
    v_mov_b32 v57, 162720
    v_lshl_add_u32 v58, v0, 18, v57
    v_add_u32 v57, 76, v57
    s_waitcnt vmcnt(6)
    ds_add_u32 v58, v56
    s_setprio 0
    s_waitcnt vmcnt(0)
    v_lshlrev_b32 v32, 16, v48
    v_lshlrev_b32 v33, 16, v49
    v_lshlrev_b32 v34, 16, v50
    v_mul_f32 v34, 1069066811, v34
    v_exp_f32 v34, v34
    v_lshlrev_b32 v37, 31, v0
    v_cvt_pk_bf16_f32 v34, v34, v34
    v_lshlrev_b32 v34, 16, v34
    v_mul_f32 v35, v34, v32
    v_mul_f32 v36, v34, v33
    v_mul_f32 v35, 1069066811, v35
    v_mul_f32 v36, 1042479491, v36
    v_exp_f32 v39, v35
    v_rndne_f32 v38, v36
    v_sub_f32 v36, v36, v38
    v_cos_f32 v144, v36
    v_sin_f32 v145, v36
    v_mul_f32 v38, v32, v32
    v_fmac_f32 v38, v33, v33
    v_rcp_f32 v38, v38
    v_mul_f32 v144, v144, v39
    v_mul_f32 v145, v145, v39
    v_add_f32 v39, -1.0, v144
    v_mul_f32 v40, v39, v32
    v_fmac_f32 v40, v145, v33
    v_mul_f32 v40, v40, v38
    v_xor_b32 v156, v37, v40
    v_mul_f32 v40, v39, v33
    v_fma_f32 v40, -v145, v32, v40
    v_mul_f32 v157, v40, v38
    v_xor_b32 v158, v37, v145
    v_xor_b32 v145, 0x80000000, v158
    v_xor_b32 v37, 0x80000000, v37
    v_mul_f32 v38, v145, v145
    v_add_f32 v39, v144, v144
    v_fma_f32 v146, v144, v144, -v38
    v_mul_f32 v147, v39, v145
    v_mul_f32 v38, v147, v147
    v_add_f32 v39, v146, v146
    v_fma_f32 v146, v146, v146, -v38
    v_mul_f32 v147, v39, v147
    v_mul_f32 v38, v147, v147
    v_add_f32 v39, v146, v146
    v_fma_f32 v146, v146, v146, -v38
    v_mul_f32 v147, v39, v147
    v_mul_f32 v38, v147, v147
    v_add_f32 v39, v146, v146
    v_fma_f32 v146, v146, v146, -v38
    v_mul_f32 v147, v39, v147
    v_mul_f32 v38, v147, v147
    v_add_f32 v39, v146, v146
    v_fma_f32 v148, v146, v146, -v38
    v_mul_f32 v149, v39, v147
    v_mul_f32 v38, v149, v149
    v_add_f32 v39, v148, v148
    v_fma_f32 v150, v148, v148, -v38
    v_mul_f32 v151, v39, v149
    v_mul_f32 v38, v151, v151
    v_add_f32 v39, v150, v150
    v_fma_f32 v152, v150, v150, -v38
    v_mul_f32 v153, v39, v151
    v_mul_f32 v38, v153, v153
    v_add_f32 v39, v152, v152
    v_fma_f32 v152, v152, v152, -v38
    v_mul_f32 v153, v39, v153
    v_mul_f32 v38, v153, v153
    v_add_f32 v39, v152, v152
    v_fma_f32 v152, v152, v152, -v38
    v_mul_f32 v153, v39, v153
    v_mul_f32 v38, v153, v153
    v_add_f32 v39, v152, v152
    v_fma_f32 v154, v152, v152, -v38
    v_mul_f32 v155, v39, v153
    v_lshlrev_b32 v32, 16, v52
    v_lshlrev_b32 v33, 16, v53
    v_lshlrev_b32 v34, 16, v54
    v_mul_f32 v34, 1069066811, v34
    v_exp_f32 v34, v34
    v_lshlrev_b32 v37, 31, v0
    v_cvt_pk_bf16_f32 v34, v34, v34
    v_lshlrev_b32 v34, 16, v34
    v_mul_f32 v35, v34, v32
    v_mul_f32 v36, v34, v33
    v_mul_f32 v35, 1069066811, v35
    v_mul_f32 v36, 1042479491, v36
    v_exp_f32 v39, v35
    v_rndne_f32 v38, v36
    v_sub_f32 v36, v36, v38
    v_cos_f32 v16, v36
    v_sin_f32 v17, v36
    v_mul_f32 v38, v32, v32
    v_fmac_f32 v38, v33, v33
    v_rcp_f32 v38, v38
    v_mul_f32 v16, v16, v39
    v_mul_f32 v17, v17, v39
    v_add_f32 v39, -1.0, v16
    v_mul_f32 v40, v39, v32
    v_fmac_f32 v40, v17, v33
    v_mul_f32 v40, v40, v38
    v_xor_b32 v66, v37, v40
    v_mul_f32 v40, v39, v33
    v_fma_f32 v40, -v17, v32, v40
    v_mul_f32 v67, v40, v38
    v_xor_b32 v18, v37, v17
    v_xor_b32 v17, 0x80000000, v18
    v_xor_b32 v37, 0x80000000, v37
    v_mul_f32 v38, v17, v17
    v_add_f32 v39, v16, v16
    v_fma_f32 v20, v16, v16, -v38
    v_mul_f32 v21, v39, v17
    v_mul_f32 v38, v21, v21
    v_add_f32 v39, v20, v20
    v_fma_f32 v20, v20, v20, -v38
    v_mul_f32 v21, v39, v21
    v_mul_f32 v38, v21, v21
    v_add_f32 v39, v20, v20
    v_fma_f32 v22, v20, v20, -v38
    v_mul_f32 v23, v39, v21
    v_mul_f32 v38, v23, v23
    v_add_f32 v39, v22, v22
    v_fma_f32 v24, v22, v22, -v38
    v_mul_f32 v25, v39, v23
    v_mul_f32 v38, v25, v25
    v_add_f32 v39, v24, v24
    v_fma_f32 v26, v24, v24, -v38
    v_mul_f32 v27, v39, v25
    v_mul_f32 v38, v27, v27
    v_add_f32 v39, v26, v26
    v_fma_f32 v28, v26, v26, -v38
    v_mul_f32 v29, v39, v27
    v_cmp_le_u32 vcc, 4, v0
    s_nop 1
    v_cndmask_b32 v20, 0, v20, vcc
    v_cndmask_b32 v21, 0, v21, vcc
    v_cmp_le_u32 vcc, 8, v0
    s_nop 1
    v_cndmask_b32 v22, 0, v22, vcc
    v_cndmask_b32 v23, 0, v23, vcc
    v_cmp_le_u32 vcc, 16, v0
    s_nop 1
    v_cndmask_b32 v24, 0, v24, vcc
    v_cndmask_b32 v25, 0, v25, vcc
    v_cmp_le_u32 vcc, 32, v0
    s_nop 1
    v_cndmask_b32 v26, 0, v26, vcc
    v_cndmask_b32 v27, 0, v27, vcc
    v_and_b32 v41, 60, v0
    v_cvt_f32_u32 v41, v41
    v_mul_f32 v38, v35, v41
    v_mul_f32 v39, v36, v41
    v_exp_f32 v38, v38
    v_rndne_f32 v40, v39
    v_sub_f32 v39, v39, v40
    v_cos_f32 v64, v39
    v_sin_f32 v65, v39
    v_xor_b32 v40, v37, v38
    v_mul_f32 v64, v64, v38
    v_mul_f32 v65, v65, v40
    v_sub_f32 v41, 1114636288, v41
    v_mul_f32 v41, 1107296256, v41
    v_mul_f32 v38, v35, v41
    v_mul_f32 v39, v36, v41
    v_exp_f32 v38, v38
    v_rndne_f32 v40, v39
    v_sub_f32 v39, v39, v40
    v_cos_f32 v30, v39
    v_sin_f32 v31, v39
    v_xor_b32 v40, v37, v38
    v_mul_f32 v30, v30, v38
    v_mul_f32 v31, v31, v40
    s_lshl_b32 s92, s80, 9
    s_add_u32 s92, s92, 4096
    s_mov_b32 s9, 4096
    s_mov_b32 s15, 0
lw_1:
    ds_read_b32 v1, v57 offset:0
    s_waitcnt lgkmcnt(0)
    v_cmp_gt_u32 vcc, 4, v1
    s_nop 0
    s_cbranch_vccz lwd_2
    s_sleep 2
    s_add_u32 s15, s15, 1
    s_cmp_lt_u32 s15, 0x100000
    s_cbranch_scc1 lw_1
lwd_2:
    s_setprio 3
    buffer_load_dword v166, v163, s[52:55], s9 offen sc1
    buffer_load_dwordx2 v[164:165], v163, s[52:55], s92 offen sc1
    s_mul_i32 s87, s4, 82944
    s_mul_i32 s8, s80, 18432
    s_add_u32 s87, s87, s8
    s_lshl_b32 s88, s80, 13
    s_add_u32 s88, s88, 115456
    s_waitcnt vmcnt(0)
    v_cmp_ne_u32 vcc, s6, v166
    s_mov_b32 s10, -1
    s_mov_b32 s11, 0xffff
    s_and_b64 vcc, vcc, s[10:11]
    s_cbranch_vccz kvjoin_3
    s_mov_b32 s15, 0
poll_5:
    buffer_load_dword v166, v163, s[52:55], s9 offen sc1
    s_waitcnt vmcnt(0)
    v_cmp_ne_u32 vcc, s6, v166
    s_nop 0
    s_and_b64 vcc, vcc, s[10:11]
    s_cbranch_vccz polld_6
    s_sleep 2
    s_add_u32 s15, s15, 1
    s_cmp_lt_u32 s15, 0x10000
    s_cbranch_scc1 poll_5
polld_6:
kvjoin_3:
    s_mov_b32 s15, 0
lw_7:
    ds_read_b32 v1, v89 offset:64
    s_waitcnt lgkmcnt(0)
    v_cmp_gt_u32 vcc, 4, v1
    s_nop 0
    s_cbranch_vccz lwd_8
    s_sleep 0
    s_add_u32 s15, s15, 1
    s_cmp_lt_u32 s15, 0x100000
    s_cbranch_scc1 lw_7
lwd_8:
    s_min_u32 s8, s80, 2
    s_lshl_b32 s14, s8, 10
    s_add_u32 m0, s14, 139776
    s_mul_i32 s14, s8, 2304
    s_add_u32 s14, s14, 70144
    buffer_load_dwordx4 v161, s[52:55], s14 offen sc1 lds
    s_mul_i32 s8, s80, 5120
    s_add_u32 m0, s8, 73728
    s_add_u32 s14, s8, 75776
    buffer_load_dwordx4 v161, s[52:55], s14 offen sc1 lds
    s_add_u32 m0, s8, 74752
    s_add_u32 s14, s8, 76800
    buffer_load_dwordx4 v161, s[52:55], s14 offen sc1 lds
    s_add_u32 m0, s8, 75776
    s_add_u32 s14, s8, 77824
    buffer_load_dwordx4 v161, s[52:55], s14 offen sc1 lds
    s_add_u32 m0, s8, 76800
    s_add_u32 s14, s8, 78848
    buffer_load_dwordx4 v161, s[52:55], s14 offen sc1 lds
    s_add_u32 m0, s8, 77824
    s_add_u32 s14, s8, 79872
    buffer_load_dwordx4 v161, s[52:55], s14 offen sc1 lds
    v_cmp_ne_u32 vcc, s6, v164
    s_nop 0
    s_cbranch_vccz flagok_4
    s_mov_b32 s15, 0
poll_9:
    buffer_load_dwordx2 v[164:165], v163, s[52:55], s92 offen sc1
    s_waitcnt vmcnt(0)
    v_cmp_ne_u32 vcc, s6, v164
    s_nop 0
    s_cbranch_vccz polld_10
    s_sleep 2
    s_add_u32 s15, s15, 1
    s_cmp_lt_u32 s15, 0x10000
    s_cbranch_scc1 poll_9
polld_10:
flagok_4:
    v_max_f32_dpp v165, v165, v165 row_ror:8 row_mask:0xf bank_mask:0xf
    s_nop 1
    v_max_f32_dpp v165, v165, v165 row_ror:4 row_mask:0xf bank_mask:0xf
    s_nop 1
    v_max_f32_dpp v165, v165, v165 row_ror:2 row_mask:0xf bank_mask:0xf
    s_nop 1
    v_max_f32_dpp v165, v165, v165 row_ror:1 row_mask:0xf bank_mask:0xf
    v_mov_b32 v2, v165
    s_nop 1
    v_permlane16_swap_b32 v2, v165
    v_max_f32 v3, v2, v165
    v_mov_b32 v2, v3
    s_nop 1
    v_permlane32_swap_b32 v2, v3
    v_max_f32 v3, v2, v3
    v_mul_f32 v3, 1065524344, v3
    ds_write_b32 v88, v3 offset:32
    s_waitcnt vmcnt(0)
    s_waitcnt lgkmcnt(0)
    s_barrier
    s_setprio 3
    s_lshl_b32 s8, s7, 2
    s_add_u32 s8, s8, s80
    s_mul_i32 s8, s8, 1280
    s_add_u32 s8, s8, 75776
    s_bfm_b64 exec, 10, 0
    buffer_load_dword v19, v90, s[52:55], s8 offen sc1
    s_mov_b64 exec, -1
    s_add_u32 s56, s50, 262144
    s_addc_u32 s57, s51, 0
    s_mov_b32 s58, 163840
    s_mov_b32 s59, 0x20000
    s_sub_u32 s89, 31, s3
    s_mul_i32 s89, s89, 5120
    v_mov_b32 v2, 162640
    s_lshl_b32 s68, s4, 2
    s_add_u32 s68, s68, s80
    s_lshl_b32 s68, s68, 7
    s_lshl_b32 s97, s3, 12
    s_add_u32 s97, s97, 7602176
    s_add_u32 s68, s68, s97
    s_mul_i32 s69, s3, 147456
    s_mul_i32 s9, s4, 9216
    s_add_u32 s69, s69, s9
    s_add_u32 s69, s69, 524288
    s_mov_b32 s15, 0
lw_11:
    ds_read_b32 v1, v2 offset:0
    s_waitcnt lgkmcnt(0)
    v_cmp_gt_u32 vcc, 5, v1
    s_nop 0
    s_cbranch_vccz lwd_12
    s_sleep 0
    s_add_u32 s15, s15, 1
    s_cmp_lt_u32 s15, 0x100000
    s_cbranch_scc1 lw_11
lwd_12:
    ds_read_b128 v[74:77], v70
    s_mov_b32 s15, 0
lw_13:
    ds_read_b32 v1, v95 offset:0
    s_waitcnt lgkmcnt(0)
    v_cmp_gt_u32 vcc, 1, v1
    s_nop 0
    s_cbranch_vccz lwd_14
    s_sleep 0
    s_add_u32 s15, s15, 1
    s_cmp_lt_u32 s15, 0x100000
    s_cbranch_scc1 lw_13
lwd_14:
    s_add_u32 s90, s84, s87
    s_add_u32 m0, s88, 0
    s_add_u32 s14, s90, 0
    buffer_load_dwordx4 v12, s[72:75], s14 offen lds
    s_add_u32 m0, s88, 1024
    s_add_u32 s14, s90, 9216
    buffer_load_dwordx4 v12, s[72:75], s14 offen lds
    s_add_u32 m0, s88, 2048
    s_add_u32 s14, s90, 0
    buffer_load_dwordx4 v13, s[76:79], s14 offen lds
    s_add_u32 m0, s88, 3072
    s_add_u32 s14, s90, 9216
    buffer_load_dwordx4 v13, s[76:79], s14 offen lds
    s_waitcnt vmcnt(4)
    s_add_u32 s90, s84, s87
    s_add_u32 m0, s88, 4096
    s_add_u32 s14, s90, 128
    buffer_load_dwordx4 v12, s[72:75], s14 offen lds
    s_waitcnt vmcnt(4)
    s_add_u32 m0, s88, 5120
    s_add_u32 s14, s90, 9344
    buffer_load_dwordx4 v12, s[72:75], s14 offen lds
    s_waitcnt vmcnt(4)
    s_add_u32 m0, s88, 6144
    s_add_u32 s14, s90, 128
    buffer_load_dwordx4 v13, s[76:79], s14 offen lds
    s_waitcnt vmcnt(4)
    s_add_u32 m0, s88, 7168
    s_add_u32 s14, s90, 9344
    buffer_load_dwordx4 v13, s[76:79], s14 offen lds
    s_waitcnt vmcnt(4)
    s_mov_b32 s64, s42
    s_mov_b32 s65, s43
    s_mov_b32 s66, 663552
    s_mov_b32 s67, 0x20000
    s_cmp_lg_u32 s80, 0
    s_cbranch_scc1 nogate_15
    v_add_u32 v1, 162816, v15
    ds_read_b32 v1, v1
    s_waitcnt lgkmcnt(0)
    v_cvt_pk_bf16_f32 v1, v1, v1
    v_lshlrev_b32 v1, 16, v1
    v_mul_f32 v1, 3216550459, v1
    v_exp_f32 v1, v1
    s_nop 0
    v_add_f32 v1, 1.0, v1
    v_rcp_f32 v1, v1
    s_nop 0
    v_cvt_pk_bf16_f32 v1, v1, v1
    v_lshlrev_b32 v2, 16, v1
    v_sub_f32 v3, 1.0, v2
    v_cvt_pk_bf16_f32 v3, v3, v3
    v_lshlrev_b32 v3, 16, v3
    v_add_f32 v1, v2, v2
    v_max_f32 v1, 562036736, v1
    v_rcp_f32 v1, v1
    s_nop 0
    v_mul_f32 v3, v3, v1
    v_add_u32 v1, 163072, v163
    ds_write_b64 v1, v[2:3]
    v_add_u32 v1, -32, v88
    v_mov_b32 v2, 255
    s_waitcnt lgkmcnt(0)
    ds_write_b32 v1, v2
nogate_15:
    s_waitcnt lgkmcnt(0)
    v_fma_f32 v79, v16, v74, v75
    v_fmac_f32_dpp v79, v74, v17 quad_perm:[1,0,3,2] row_mask:0xf bank_mask:0xf
    v_fma_f32 v80, v16, v79, v76
    s_nop 0
    v_fmac_f32_dpp v80, v79, v17 quad_perm:[1,0,3,2] row_mask:0xf bank_mask:0xf
    v_fma_f32 v79, v16, v80, v77
    s_nop 0
    v_fmac_f32_dpp v79, v80, v17 quad_perm:[1,0,3,2] row_mask:0xf bank_mask:0xf
    ds_bpermute_b32 v80, v15, v79 offset:240
    s_waitcnt lgkmcnt(0)
    v_fma_f32 v79, v20, v80, v79
    v_fmac_f32_dpp v79, v80, v21 quad_perm:[1,0,3,2] row_mask:0xf bank_mask:0xf
    ds_bpermute_b32 v80, v15, v79 offset:224
    s_waitcnt lgkmcnt(0)
    v_fma_f32 v79, v22, v80, v79
    v_fmac_f32_dpp v79, v80, v23 quad_perm:[1,0,3,2] row_mask:0xf bank_mask:0xf
    ds_bpermute_b32 v80, v15, v79 offset:192
    s_waitcnt lgkmcnt(0)
    v_fma_f32 v79, v24, v80, v79
    v_fmac_f32_dpp v79, v80, v25 quad_perm:[1,0,3,2] row_mask:0xf bank_mask:0xf
    ds_bpermute_b32 v80, v15, v79 offset:128
    s_waitcnt lgkmcnt(0)
    v_fma_f32 v79, v26, v80, v79
    v_fmac_f32_dpp v79, v80, v27 quad_perm:[1,0,3,2] row_mask:0xf bank_mask:0xf
    buffer_store_dword v79, v71, s[56:59], s89 offen sc1
    ds_bpermute_b32 v78, v15, v79 offset:240
    s_waitcnt lgkmcnt(0)
    s_mov_b64 vcc, 15
    v_cndmask_b32 v78, v78, 0, vcc
    v_mul_f32 v20, v66, v74
    v_fmac_f32_dpp v20, v74, v67 quad_perm:[1,0,3,2] row_mask:0xf bank_mask:0xf
    v_mul_f32 v21, v66, v75
    v_fmac_f32_dpp v21, v75, v67 quad_perm:[1,0,3,2] row_mask:0xf bank_mask:0xf
    v_mul_f32 v22, v66, v76
    v_fmac_f32_dpp v22, v76, v67 quad_perm:[1,0,3,2] row_mask:0xf bank_mask:0xf
    v_mul_f32 v23, v66, v77
    v_fmac_f32_dpp v23, v77, v67 quad_perm:[1,0,3,2] row_mask:0xf bank_mask:0xf
    ds_read_b128 v[96:99], v8 offset:0
    ds_read_b128 v[100:103], v9 offset:0
    ds_read_b128 v[104:107], v10 offset:0
    ds_read_b128 v[108:111], v11 offset:0
    s_waitcnt lgkmcnt(0)
    s_add_u32 s90, s84, s87
    s_add_u32 m0, s88, 0
    s_add_u32 s14, s90, 256
    buffer_load_dwordx4 v12, s[72:75], s14 offen lds
    s_waitcnt vmcnt(4)
    s_add_u32 m0, s88, 1024
    s_add_u32 s14, s90, 9472
    buffer_load_dwordx4 v12, s[72:75], s14 offen lds
    s_waitcnt vmcnt(4)
    s_add_u32 m0, s88, 2048
    s_add_u32 s14, s90, 256
    buffer_load_dwordx4 v13, s[76:79], s14 offen lds
    s_waitcnt vmcnt(4)
    s_add_u32 m0, s88, 3072
    s_add_u32 s14, s90, 9472
    buffer_load_dwordx4 v13, s[76:79], s14 offen lds
    s_waitcnt vmcnt(4)
    ds_read_b128 v[128:131], v4 offset:0
    ds_read_b128 v[132:135], v4 offset:4096
    ds_read_b128 v[136:139], v5 offset:0
    ds_read_b128 v[112:115], v8 offset:4096
    ds_read_b128 v[116:119], v9 offset:4096
    ds_read_b128 v[120:123], v10 offset:4096
    ds_read_b128 v[124:127], v11 offset:4096
    s_waitcnt lgkmcnt(0)
    s_add_u32 s90, s85, s87
    s_add_u32 m0, s88, 4096
    s_add_u32 s14, s90, 0
    buffer_load_dwordx4 v12, s[72:75], s14 offen lds
    s_waitcnt vmcnt(4)
    s_add_u32 m0, s88, 5120
    s_add_u32 s14, s90, 9216
    buffer_load_dwordx4 v12, s[72:75], s14 offen lds
    s_waitcnt vmcnt(4)
    s_add_u32 m0, s88, 6144
    s_add_u32 s14, s90, 0
    buffer_load_dwordx4 v13, s[76:79], s14 offen lds
    s_waitcnt vmcnt(4)
    s_add_u32 m0, s88, 7168
    s_add_u32 s14, s90, 9216
    buffer_load_dwordx4 v13, s[76:79], s14 offen lds
    s_waitcnt vmcnt(4)
    ds_read_b128 v[140:143], v5 offset:4096
    v_mfma_f32_32x32x16_bf16 v[32:47], v[128:131], v[96:99], 0
    ds_read_b128 v[128:131], v6 offset:0
    v_mfma_f32_32x32x16_bf16 v[48:63], v[132:135], v[96:99], 0
    ds_read_b128 v[132:135], v6 offset:4096
    v_mfma_f32_32x32x16_bf16 v[32:47], v[136:139], v[100:103], v[32:47]
    ds_read_b128 v[136:139], v7 offset:0
    s_waitcnt lgkmcnt(3)
    v_mfma_f32_32x32x16_bf16 v[48:63], v[140:143], v[100:103], v[48:63]
    ds_read_b128 v[140:143], v7 offset:4096
    s_waitcnt lgkmcnt(3)
    v_mfma_f32_32x32x16_bf16 v[32:47], v[128:131], v[104:107], v[32:47]
    ds_read_b128 v[128:131], v4 offset:8192
    s_waitcnt lgkmcnt(3)
    v_mfma_f32_32x32x16_bf16 v[48:63], v[132:135], v[104:107], v[48:63]
    ds_read_b128 v[132:135], v4 offset:12288
    s_waitcnt lgkmcnt(3)
    v_mfma_f32_32x32x16_bf16 v[32:47], v[136:139], v[108:111], v[32:47]
    ds_read_b128 v[136:139], v5 offset:8192
    s_waitcnt lgkmcnt(3)
    v_mfma_f32_32x32x16_bf16 v[48:63], v[140:143], v[108:111], v[48:63]
    ds_read_b128 v[96:99], v8 offset:0
    ds_read_b128 v[100:103], v9 offset:0
    ds_read_b128 v[104:107], v10 offset:0
    ds_read_b128 v[108:111], v11 offset:0
    s_waitcnt lgkmcnt(0)
    s_add_u32 s90, s85, s87
    s_add_u32 m0, s88, 0
    s_add_u32 s14, s90, 128
    buffer_load_dwordx4 v12, s[72:75], s14 offen lds
    s_waitcnt vmcnt(4)
    s_add_u32 m0, s88, 1024
    s_add_u32 s14, s90, 9344
    buffer_load_dwordx4 v12, s[72:75], s14 offen lds
    s_waitcnt vmcnt(4)
    s_add_u32 m0, s88, 2048
    s_add_u32 s14, s90, 128
    buffer_load_dwordx4 v13, s[76:79], s14 offen lds
    s_waitcnt vmcnt(4)
    s_add_u32 m0, s88, 3072
    s_add_u32 s14, s90, 9344
    buffer_load_dwordx4 v13, s[76:79], s14 offen lds
    s_waitcnt vmcnt(4)
    ds_read_b128 v[140:143], v5 offset:12288
    v_mfma_f32_32x32x16_bf16 v[32:47], v[128:131], v[112:115], v[32:47]
    ds_read_b128 v[128:131], v6 offset:8192
    v_mfma_f32_32x32x16_bf16 v[48:63], v[132:135], v[112:115], v[48:63]
    ds_read_b128 v[132:135], v6 offset:12288
    v_mfma_f32_32x32x16_bf16 v[32:47], v[136:139], v[116:119], v[32:47]
    ds_read_b128 v[136:139], v7 offset:8192
    s_waitcnt lgkmcnt(3)
    v_mfma_f32_32x32x16_bf16 v[48:63], v[140:143], v[116:119], v[48:63]
    ds_read_b128 v[140:143], v7 offset:12288
    s_waitcnt lgkmcnt(3)
    v_mfma_f32_32x32x16_bf16 v[32:47], v[128:131], v[120:123], v[32:47]
    ds_read_b128 v[128:131], v4 offset:16384
    s_waitcnt lgkmcnt(3)
    v_mfma_f32_32x32x16_bf16 v[48:63], v[132:135], v[120:123], v[48:63]
    ds_read_b128 v[132:135], v4 offset:20480
    s_waitcnt lgkmcnt(3)
    v_mfma_f32_32x32x16_bf16 v[32:47], v[136:139], v[124:127], v[32:47]
    ds_read_b128 v[136:139], v5 offset:16384
    s_waitcnt lgkmcnt(3)
    v_mfma_f32_32x32x16_bf16 v[48:63], v[140:143], v[124:127], v[48:63]
    ds_read_b128 v[112:115], v8 offset:4096
    ds_read_b128 v[116:119], v9 offset:4096
    ds_read_b128 v[120:123], v10 offset:4096
    ds_read_b128 v[124:127], v11 offset:4096
    s_waitcnt lgkmcnt(0)
    s_add_u32 s90, s85, s87
    s_add_u32 m0, s88, 4096
    s_add_u32 s14, s90, 256
    buffer_load_dwordx4 v12, s[72:75], s14 offen lds
    s_waitcnt vmcnt(4)
    s_add_u32 m0, s88, 5120
    s_add_u32 s14, s90, 9472
    buffer_load_dwordx4 v12, s[72:75], s14 offen lds
    s_waitcnt vmcnt(4)
    s_add_u32 m0, s88, 6144
    s_add_u32 s14, s90, 256
    buffer_load_dwordx4 v13, s[76:79], s14 offen lds
    s_waitcnt vmcnt(4)
    s_add_u32 m0, s88, 7168
    s_add_u32 s14, s90, 9472
    buffer_load_dwordx4 v13, s[76:79], s14 offen lds
    s_waitcnt vmcnt(4)
    ds_read_b128 v[140:143], v5 offset:20480
    v_mfma_f32_32x32x16_bf16 v[32:47], v[128:131], v[96:99], v[32:47]
    ds_read_b128 v[128:131], v6 offset:16384
    v_mfma_f32_32x32x16_bf16 v[48:63], v[132:135], v[96:99], v[48:63]
    ds_read_b128 v[132:135], v6 offset:20480
    v_mfma_f32_32x32x16_bf16 v[32:47], v[136:139], v[100:103], v[32:47]
    ds_read_b128 v[136:139], v7 offset:16384
    s_waitcnt lgkmcnt(3)
    v_mfma_f32_32x32x16_bf16 v[48:63], v[140:143], v[100:103], v[48:63]
    ds_read_b128 v[140:143], v7 offset:20480
    s_waitcnt lgkmcnt(3)
    v_mfma_f32_32x32x16_bf16 v[32:47], v[128:131], v[104:107], v[32:47]
    ds_read_b128 v[128:131], v4 offset:24576
    s_waitcnt lgkmcnt(3)
    v_mfma_f32_32x32x16_bf16 v[48:63], v[132:135], v[104:107], v[48:63]
    ds_read_b128 v[132:135], v4 offset:28672
    s_waitcnt lgkmcnt(3)
    v_mfma_f32_32x32x16_bf16 v[32:47], v[136:139], v[108:111], v[32:47]
    ds_read_b128 v[136:139], v5 offset:24576
    s_waitcnt lgkmcnt(3)
    v_mfma_f32_32x32x16_bf16 v[48:63], v[140:143], v[108:111], v[48:63]
    ds_read_b128 v[96:99], v8 offset:0
    ds_read_b128 v[100:103], v9 offset:0
    ds_read_b128 v[104:107], v10 offset:0
    ds_read_b128 v[108:111], v11 offset:0
    s_waitcnt lgkmcnt(0)
    s_add_u32 s90, s86, s87
    s_add_u32 m0, s88, 0
    s_add_u32 s14, s90, 0
    buffer_load_dwordx4 v12, s[72:75], s14 offen lds
    s_waitcnt vmcnt(4)
    s_add_u32 m0, s88, 1024
    s_add_u32 s14, s90, 9216
    buffer_load_dwordx4 v12, s[72:75], s14 offen lds
    s_waitcnt vmcnt(4)
    s_add_u32 m0, s88, 2048
    s_add_u32 s14, s90, 0
    buffer_load_dwordx4 v13, s[76:79], s14 offen lds
    s_waitcnt vmcnt(4)
    s_add_u32 m0, s88, 3072
    s_add_u32 s14, s90, 9216
    buffer_load_dwordx4 v13, s[76:79], s14 offen lds
    s_waitcnt vmcnt(4)
    v_mov_b32 v162, -1
    v_mov_b32 v163, -1
    v_mov_b32 v164, -1
    v_mov_b32 v165, -1
    s_mul_i32 s8, s3, 73728
    s_add_u32 s8, s8, 5242880
    s_lshl_b32 s9, s4, 2
    s_add_u32 s9, s9, s80
    s_lshl_b32 s10, s9, 11
    s_add_u32 s10, s10, s8
    buffer_store_dwordx4 v[162:165], v161, s[52:55], s10 offen sc1
    buffer_store_dwordx4 v[162:165], v161, s[52:55], s10 offen offset:1024 sc1
    s_lshl_b32 s9, s9, 8
    s_add_u32 s8, s8, s9
    s_add_u32 s8, s8, 65536
    buffer_store_dword v162, v15, s[52:55], s8 offen sc1
    ds_read_b128 v[140:143], v5 offset:28672
    v_mfma_f32_32x32x16_bf16 v[32:47], v[128:131], v[112:115], v[32:47]
    ds_read_b128 v[128:131], v6 offset:24576
    v_mfma_f32_32x32x16_bf16 v[48:63], v[132:135], v[112:115], v[48:63]
    ds_read_b128 v[132:135], v6 offset:28672
    v_mfma_f32_32x32x16_bf16 v[32:47], v[136:139], v[116:119], v[32:47]
    ds_read_b128 v[136:139], v7 offset:24576
    s_waitcnt lgkmcnt(3)
    v_mfma_f32_32x32x16_bf16 v[48:63], v[140:143], v[116:119], v[48:63]
    ds_read_b128 v[140:143], v7 offset:28672
    s_waitcnt lgkmcnt(3)
    v_mfma_f32_32x32x16_bf16 v[32:47], v[128:131], v[120:123], v[32:47]
    ds_read_b128 v[128:131], v4 offset:32768
    s_waitcnt lgkmcnt(3)
    v_mfma_f32_32x32x16_bf16 v[48:63], v[132:135], v[120:123], v[48:63]
    ds_read_b128 v[132:135], v4 offset:36864
    s_waitcnt lgkmcnt(3)
    v_mfma_f32_32x32x16_bf16 v[32:47], v[136:139], v[124:127], v[32:47]
    ds_read_b128 v[136:139], v5 offset:32768
    s_waitcnt lgkmcnt(3)
    v_mfma_f32_32x32x16_bf16 v[48:63], v[140:143], v[124:127], v[48:63]
    ds_read_b128 v[112:115], v8 offset:4096
    ds_read_b128 v[116:119], v9 offset:4096
    ds_read_b128 v[120:123], v10 offset:4096
    ds_read_b128 v[124:127], v11 offset:4096
    s_waitcnt lgkmcnt(0)
    s_add_u32 s90, s86, s87
    s_add_u32 m0, s88, 4096
    s_add_u32 s14, s90, 128
    buffer_load_dwordx4 v12, s[72:75], s14 offen lds
    s_waitcnt vmcnt(4)
    s_add_u32 m0, s88, 5120
    s_add_u32 s14, s90, 9344
    buffer_load_dwordx4 v12, s[72:75], s14 offen lds
    s_waitcnt vmcnt(4)
    s_add_u32 m0, s88, 6144
    s_add_u32 s14, s90, 128
    buffer_load_dwordx4 v13, s[76:79], s14 offen lds
    s_waitcnt vmcnt(4)
    s_add_u32 m0, s88, 7168
    s_add_u32 s14, s90, 9344
    buffer_load_dwordx4 v13, s[76:79], s14 offen lds
    s_waitcnt vmcnt(4)
    ds_read_b128 v[140:143], v5 offset:36864
    v_mfma_f32_32x32x16_bf16 v[32:47], v[128:131], v[96:99], v[32:47]
    ds_read_b128 v[128:131], v6 offset:32768
    v_mfma_f32_32x32x16_bf16 v[48:63], v[132:135], v[96:99], v[48:63]
    ds_read_b128 v[132:135], v6 offset:36864
    v_mfma_f32_32x32x16_bf16 v[32:47], v[136:139], v[100:103], v[32:47]
    ds_read_b128 v[136:139], v7 offset:32768
    s_waitcnt lgkmcnt(3)
    v_mfma_f32_32x32x16_bf16 v[48:63], v[140:143], v[100:103], v[48:63]
    ds_read_b128 v[140:143], v7 offset:36864
    s_waitcnt lgkmcnt(3)
    v_mfma_f32_32x32x16_bf16 v[32:47], v[128:131], v[104:107], v[32:47]
    ds_read_b128 v[128:131], v4 offset:40960
    s_waitcnt lgkmcnt(3)
    v_mfma_f32_32x32x16_bf16 v[48:63], v[132:135], v[104:107], v[48:63]
    ds_read_b128 v[132:135], v4 offset:45056
    s_waitcnt lgkmcnt(3)
    v_mfma_f32_32x32x16_bf16 v[32:47], v[136:139], v[108:111], v[32:47]
    ds_read_b128 v[136:139], v5 offset:40960
    s_waitcnt lgkmcnt(3)
    v_mfma_f32_32x32x16_bf16 v[48:63], v[140:143], v[108:111], v[48:63]
    ds_read_b128 v[96:99], v8 offset:0
    ds_read_b128 v[100:103], v9 offset:0
    ds_read_b128 v[104:107], v10 offset:0
    ds_read_b128 v[108:111], v11 offset:0
    s_waitcnt lgkmcnt(0)
    s_add_u32 s90, s86, s87
    s_add_u32 m0, s88, 0
    s_add_u32 s14, s90, 256
    buffer_load_dwordx4 v12, s[72:75], s14 offen lds
    s_waitcnt vmcnt(4)
    s_add_u32 m0, s88, 1024
    s_add_u32 s14, s90, 9472
    buffer_load_dwordx4 v12, s[72:75], s14 offen lds
    s_waitcnt vmcnt(4)
    s_add_u32 m0, s88, 2048
    s_add_u32 s14, s90, 256
    buffer_load_dwordx4 v13, s[76:79], s14 offen lds
    s_waitcnt vmcnt(4)
    s_add_u32 m0, s88, 3072
    s_add_u32 s14, s90, 9472
    buffer_load_dwordx4 v13, s[76:79], s14 offen lds
    s_waitcnt vmcnt(4)
    s_lshl_b32 s8, s7, 2
    s_add_u32 s8, s8, s80
    s_mul_i32 s8, s8, 5248
    s_add_u32 s8, s8, 0
    s_bfm_b64 exec, 14, 0
    buffer_load_dword v19, v90, s[64:67], s8 offen
    s_mov_b64 exec, -1
    ds_read_b128 v[140:143], v5 offset:45056
    v_mfma_f32_32x32x16_bf16 v[32:47], v[128:131], v[112:115], v[32:47]
    ds_read_b128 v[128:131], v6 offset:40960
    v_mfma_f32_32x32x16_bf16 v[48:63], v[132:135], v[112:115], v[48:63]
    ds_read_b128 v[132:135], v6 offset:45056
    v_mfma_f32_32x32x16_bf16 v[32:47], v[136:139], v[116:119], v[32:47]
    ds_read_b128 v[136:139], v7 offset:40960
    s_waitcnt lgkmcnt(3)
    v_mfma_f32_32x32x16_bf16 v[48:63], v[140:143], v[116:119], v[48:63]
    ds_read_b128 v[140:143], v7 offset:45056
    s_waitcnt lgkmcnt(3)
    v_mfma_f32_32x32x16_bf16 v[32:47], v[128:131], v[120:123], v[32:47]
    ds_read_b128 v[128:131], v4 offset:49152
    s_waitcnt lgkmcnt(3)
    v_mfma_f32_32x32x16_bf16 v[48:63], v[132:135], v[120:123], v[48:63]
    ds_read_b128 v[132:135], v4 offset:53248
    s_waitcnt lgkmcnt(3)
    v_mfma_f32_32x32x16_bf16 v[32:47], v[136:139], v[124:127], v[32:47]
    ds_read_b128 v[136:139], v5 offset:49152
    s_waitcnt lgkmcnt(3)
    v_mfma_f32_32x32x16_bf16 v[48:63], v[140:143], v[124:127], v[48:63]
    ds_read_b128 v[112:115], v8 offset:4096
    ds_read_b128 v[116:119], v9 offset:4096
    ds_read_b128 v[120:123], v10 offset:4096
    ds_read_b128 v[124:127], v11 offset:4096
    s_waitcnt lgkmcnt(0)
    s_lshl_b32 s8, s7, 2
    s_add_u32 s8, s8, s80
    s_mul_i32 s8, s8, 5248
    s_add_u32 s8, s8, 1792
    s_bfm_b64 exec, 14, 0
    buffer_load_dword v19, v90, s[64:67], s8 offen
    s_mov_b64 exec, -1
    ds_read_b128 v[140:143], v5 offset:53248
    v_mfma_f32_32x32x16_bf16 v[32:47], v[128:131], v[96:99], v[32:47]
    ds_read_b128 v[128:131], v6 offset:49152
    v_mfma_f32_32x32x16_bf16 v[48:63], v[132:135], v[96:99], v[48:63]
    ds_read_b128 v[132:135], v6 offset:53248
    v_mfma_f32_32x32x16_bf16 v[32:47], v[136:139], v[100:103], v[32:47]
    ds_read_b128 v[136:139], v7 offset:49152
    s_waitcnt lgkmcnt(3)
    v_mfma_f32_32x32x16_bf16 v[48:63], v[140:143], v[100:103], v[48:63]
    ds_read_b128 v[140:143], v7 offset:53248
    s_waitcnt lgkmcnt(3)
    v_mfma_f32_32x32x16_bf16 v[32:47], v[128:131], v[104:107], v[32:47]
    ds_read_b128 v[128:131], v4 offset:57344
    s_waitcnt lgkmcnt(3)
    v_mfma_f32_32x32x16_bf16 v[48:63], v[132:135], v[104:107], v[48:63]
    ds_read_b128 v[132:135], v4 offset:61440
    s_waitcnt lgkmcnt(3)
    v_mfma_f32_32x32x16_bf16 v[32:47], v[136:139], v[108:111], v[32:47]
    ds_read_b128 v[136:139], v5 offset:57344
    s_waitcnt lgkmcnt(3)
    v_mfma_f32_32x32x16_bf16 v[48:63], v[140:143], v[108:111], v[48:63]
    s_waitcnt vmcnt(2)
    ds_read_b128 v[96:99], v8 offset:0
    ds_read_b128 v[100:103], v9 offset:0
    ds_read_b128 v[104:107], v10 offset:0
    ds_read_b128 v[108:111], v11 offset:0
    s_waitcnt lgkmcnt(0)
    s_lshl_b32 s8, s7, 2
    s_add_u32 s8, s8, s80
    s_mul_i32 s8, s8, 5248
    s_add_u32 s8, s8, 3584
    s_bfm_b64 exec, 14, 0
    buffer_load_dword v19, v90, s[64:67], s8 offen
    s_mov_b64 exec, -1
    s_add_u32 s9, s69, 8192
    buffer_load_dword v19, v73, s[52:55], s9 offen sc1
    ds_read_b128 v[140:143], v5 offset:61440
    v_mfma_f32_32x32x16_bf16 v[32:47], v[128:131], v[112:115], v[32:47]
    ds_read_b128 v[128:131], v6 offset:57344
    v_mfma_f32_32x32x16_bf16 v[48:63], v[132:135], v[112:115], v[48:63]
    ds_read_b128 v[132:135], v6 offset:61440
    v_mfma_f32_32x32x16_bf16 v[32:47], v[136:139], v[116:119], v[32:47]
    ds_read_b128 v[136:139], v7 offset:57344
    s_waitcnt lgkmcnt(3)
    v_mfma_f32_32x32x16_bf16 v[48:63], v[140:143], v[116:119], v[48:63]
    ds_read_b128 v[140:143], v7 offset:61440
    s_waitcnt lgkmcnt(3)
    v_mfma_f32_32x32x16_bf16 v[32:47], v[128:131], v[120:123], v[32:47]
    v_add_u32 v4, 65536, v4
    v_add_u32 v5, 65536, v5
    v_add_u32 v6, 65536, v6
    v_add_u32 v7, 65536, v7
    ds_read_b128 v[128:131], v4 offset:0
    s_waitcnt lgkmcnt(3)
    v_mfma_f32_32x32x16_bf16 v[48:63], v[132:135], v[120:123], v[48:63]
    ds_read_b128 v[132:135], v4 offset:4096
    s_waitcnt lgkmcnt(3)
    v_mfma_f32_32x32x16_bf16 v[32:47], v[136:139], v[124:127], v[32:47]
    ds_read_b128 v[136:139], v5 offset:0
    s_waitcnt lgkmcnt(3)
    v_mfma_f32_32x32x16_bf16 v[48:63], v[140:143], v[124:127], v[48:63]
    ds_read_b128 v[140:143], v5 offset:4096
    s_waitcnt lgkmcnt(3)
    v_mfma_f32_32x32x16_bf16 v[32:47], v[128:131], v[96:99], v[32:47]
    ds_read_b128 v[128:131], v6 offset:0
    s_waitcnt lgkmcnt(3)
    v_mfma_f32_32x32x16_bf16 v[48:63], v[132:135], v[96:99], v[48:63]
    ds_read_b128 v[132:135], v6 offset:4096
    s_waitcnt lgkmcnt(3)
    v_mfma_f32_32x32x16_bf16 v[32:47], v[136:139], v[100:103], v[32:47]
    ds_read_b128 v[136:139], v7 offset:0
    s_waitcnt lgkmcnt(3)
    v_mfma_f32_32x32x16_bf16 v[48:63], v[140:143], v[100:103], v[48:63]
    ds_read_b128 v[140:143], v7 offset:4096
    s_waitcnt lgkmcnt(3)
    v_mfma_f32_32x32x16_bf16 v[32:47], v[128:131], v[104:107], v[32:47]
    s_waitcnt lgkmcnt(2)
    v_mfma_f32_32x32x16_bf16 v[48:63], v[132:135], v[104:107], v[48:63]
    s_waitcnt lgkmcnt(1)
    v_mfma_f32_32x32x16_bf16 v[32:47], v[136:139], v[108:111], v[32:47]
    s_waitcnt lgkmcnt(0)
    v_mfma_f32_32x32x16_bf16 v[48:63], v[140:143], v[108:111], v[48:63]
    s_setprio 3
    v_mov_b32 v1, 1
    ds_write_b32 v88, v1
    v_mov_b32 v2, 255
    v_add_u32 v3, -28, v88
    ds_write_b32 v3, v2
    s_nop 3
    v_fma_f32 v164, v144, v32, v33
    s_nop 0
    v_fma_f32 v165, v144, v48, v49
    v_fmac_f32_dpp v164, v32, v145 quad_perm:[1,0,3,2] row_mask:0xf bank_mask:0xf
    v_fmac_f32_dpp v165, v48, v145 quad_perm:[1,0,3,2] row_mask:0xf bank_mask:0xf
    v_fma_f32 v162, v144, v164, v34
    v_fma_f32 v163, v144, v165, v50
    v_fmac_f32_dpp v162, v164, v145 quad_perm:[1,0,3,2] row_mask:0xf bank_mask:0xf
    v_fmac_f32_dpp v163, v165, v145 quad_perm:[1,0,3,2] row_mask:0xf bank_mask:0xf
    v_fma_f32 v164, v144, v162, v35
    v_fma_f32 v165, v144, v163, v51
    v_fmac_f32_dpp v164, v162, v145 quad_perm:[1,0,3,2] row_mask:0xf bank_mask:0xf
    v_fmac_f32_dpp v165, v163, v145 quad_perm:[1,0,3,2] row_mask:0xf bank_mask:0xf
    v_fma_f32 v162, v144, v164, v36
    v_fma_f32 v163, v144, v165, v52
    v_fmac_f32_dpp v162, v164, v145 quad_perm:[1,0,3,2] row_mask:0xf bank_mask:0xf
    v_fmac_f32_dpp v163, v165, v145 quad_perm:[1,0,3,2] row_mask:0xf bank_mask:0xf
    v_fma_f32 v164, v144, v162, v37
    v_fma_f32 v165, v144, v163, v53
    v_fmac_f32_dpp v164, v162, v145 quad_perm:[1,0,3,2] row_mask:0xf bank_mask:0xf
    v_fmac_f32_dpp v165, v163, v145 quad_perm:[1,0,3,2] row_mask:0xf bank_mask:0xf
    v_fma_f32 v162, v144, v164, v38
    v_fma_f32 v163, v144, v165, v54
    v_fmac_f32_dpp v162, v164, v145 quad_perm:[1,0,3,2] row_mask:0xf bank_mask:0xf
    v_fmac_f32_dpp v163, v165, v145 quad_perm:[1,0,3,2] row_mask:0xf bank_mask:0xf
    v_fma_f32 v164, v144, v162, v39
    v_fma_f32 v165, v144, v163, v55
    v_fmac_f32_dpp v164, v162, v145 quad_perm:[1,0,3,2] row_mask:0xf bank_mask:0xf
    v_fmac_f32_dpp v165, v163, v145 quad_perm:[1,0,3,2] row_mask:0xf bank_mask:0xf
    v_fma_f32 v162, v144, v164, v40
    v_fma_f32 v163, v144, v165, v56
    v_fmac_f32_dpp v162, v164, v145 quad_perm:[1,0,3,2] row_mask:0xf bank_mask:0xf
    v_fmac_f32_dpp v163, v165, v145 quad_perm:[1,0,3,2] row_mask:0xf bank_mask:0xf
    v_fma_f32 v164, v144, v162, v41
    v_fma_f32 v165, v144, v163, v57
    v_fmac_f32_dpp v164, v162, v145 quad_perm:[1,0,3,2] row_mask:0xf bank_mask:0xf
    v_fmac_f32_dpp v165, v163, v145 quad_perm:[1,0,3,2] row_mask:0xf bank_mask:0xf
    v_fma_f32 v162, v144, v164, v42
    v_fma_f32 v163, v144, v165, v58
    v_fmac_f32_dpp v162, v164, v145 quad_perm:[1,0,3,2] row_mask:0xf bank_mask:0xf
    v_fmac_f32_dpp v163, v165, v145 quad_perm:[1,0,3,2] row_mask:0xf bank_mask:0xf
    v_fma_f32 v164, v144, v162, v43
    v_fma_f32 v165, v144, v163, v59
    v_fmac_f32_dpp v164, v162, v145 quad_perm:[1,0,3,2] row_mask:0xf bank_mask:0xf
    v_fmac_f32_dpp v165, v163, v145 quad_perm:[1,0,3,2] row_mask:0xf bank_mask:0xf
    v_fma_f32 v162, v144, v164, v44
    v_fma_f32 v163, v144, v165, v60
    v_fmac_f32_dpp v162, v164, v145 quad_perm:[1,0,3,2] row_mask:0xf bank_mask:0xf
    v_fmac_f32_dpp v163, v165, v145 quad_perm:[1,0,3,2] row_mask:0xf bank_mask:0xf
    v_fma_f32 v164, v144, v162, v45
    v_fma_f32 v165, v144, v163, v61
    v_fmac_f32_dpp v164, v162, v145 quad_perm:[1,0,3,2] row_mask:0xf bank_mask:0xf
    v_fmac_f32_dpp v165, v163, v145 quad_perm:[1,0,3,2] row_mask:0xf bank_mask:0xf
    v_fma_f32 v162, v144, v164, v46
    v_fma_f32 v163, v144, v165, v62
    v_fmac_f32_dpp v162, v164, v145 quad_perm:[1,0,3,2] row_mask:0xf bank_mask:0xf
    v_fmac_f32_dpp v163, v165, v145 quad_perm:[1,0,3,2] row_mask:0xf bank_mask:0xf
    v_fma_f32 v91, v144, v162, v47
    v_fma_f32 v165, v144, v163, v63
    v_fmac_f32_dpp v91, v162, v145 quad_perm:[1,0,3,2] row_mask:0xf bank_mask:0xf
    v_fmac_f32_dpp v165, v163, v145 quad_perm:[1,0,3,2] row_mask:0xf bank_mask:0xf
    v_fma_f32 v92, v146, v91, v165
    v_fmac_f32_dpp v92, v91, v147 quad_perm:[1,0,3,2] row_mask:0xf bank_mask:0xf
    v_mov_b32 v159, v92
    s_nop 1
    v_permlane32_swap_b32 v92, v159
    v_fma_f32 v160, v148, v92, v159
    s_nop 0
    v_fmac_f32_dpp v160, v92, v149 quad_perm:[1,0,3,2] row_mask:0xf bank_mask:0xf
    buffer_store_dword v160, v84, s[56:59], s89 offen sc1
    s_cmp_eq_u32 s81, 0
    s_cselect_b32 s60, s26, s28
    s_cselect_b32 s61, s27, s29
    s_mov_b32 s62, 663552
    s_mov_b32 s63, 0x20000
    s_mul_i32 s84, s4, 82944
    s_mul_i32 s85, s80, 18432
    s_mov_b32 s86, 4
    s_mul_i32 s9, s82, 5
    s_add_u32 s8, s3, 0
    s_and_b32 s8, s8, 3
    s_add_u32 s87, s8, s9
    s_add_u32 s8, s3, 1
    s_and_b32 s8, s8, 3
    s_add_u32 s88, s8, s9
    s_add_u32 s8, s3, 2
    s_and_b32 s8, s8, 3
    s_add_u32 s89, s8, s9
    s_add_u32 s8, s3, 3
    s_and_b32 s8, s8, 3
    s_add_u32 s90, s8, s9
    s_mov_b32 s15, 0
lw_16:
    ds_read_b32 v1, v89 offset:0
    s_waitcnt lgkmcnt(0)
    v_cmp_gt_u32 vcc, 1, v1
    s_nop 0
    s_cbranch_vccz lwd_17
    s_sleep 2
    s_add_u32 s15, s15, 1
    s_cmp_lt_u32 s15, 0x100000
    s_cbranch_scc1 lw_16
lwd_17:
    s_lshl_b32 s93, s87, 7
    s_add_u32 s93, s93, s84
    s_add_u32 m0, s85, 9216
    s_add_u32 s14, s93, 0
    buffer_load_dwordx4 v12, s[60:63], s14 offen lds
    s_add_u32 m0, s85, 10240
    s_add_u32 s14, s93, 9216
    buffer_load_dwordx4 v13, s[60:63], s14 offen lds
    s_add_u32 m0, s85, 11264
    s_add_u32 s14, s93, 18432
    buffer_load_dwordx4 v12, s[60:63], s14 offen lds
    v_mul_f32 v96, v156, v32
    v_mul_f32 v97, v156, v33
    v_fmac_f32_dpp v96, v32, v157 quad_perm:[1,0,3,2] row_mask:0xf bank_mask:0xf
    v_fmac_f32_dpp v97, v33, v157 quad_perm:[1,0,3,2] row_mask:0xf bank_mask:0xf
    v_mul_f32 v98, v156, v34
    v_mul_f32 v99, v156, v35
    v_fmac_f32_dpp v98, v34, v157 quad_perm:[1,0,3,2] row_mask:0xf bank_mask:0xf
    v_fmac_f32_dpp v99, v35, v157 quad_perm:[1,0,3,2] row_mask:0xf bank_mask:0xf
    v_mul_f32 v100, v156, v36
    v_mul_f32 v101, v156, v37
    v_fmac_f32_dpp v100, v36, v157 quad_perm:[1,0,3,2] row_mask:0xf bank_mask:0xf
    v_fmac_f32_dpp v101, v37, v157 quad_perm:[1,0,3,2] row_mask:0xf bank_mask:0xf
    v_mul_f32 v102, v156, v38
    v_mul_f32 v103, v156, v39
    v_fmac_f32_dpp v102, v38, v157 quad_perm:[1,0,3,2] row_mask:0xf bank_mask:0xf
    v_fmac_f32_dpp v103, v39, v157 quad_perm:[1,0,3,2] row_mask:0xf bank_mask:0xf
    v_mul_f32 v104, v156, v40
    v_mul_f32 v105, v156, v41
    v_fmac_f32_dpp v104, v40, v157 quad_perm:[1,0,3,2] row_mask:0xf bank_mask:0xf
    v_fmac_f32_dpp v105, v41, v157 quad_perm:[1,0,3,2] row_mask:0xf bank_mask:0xf
    v_mul_f32 v106, v156, v42
    v_mul_f32 v107, v156, v43
    v_fmac_f32_dpp v106, v42, v157 quad_perm:[1,0,3,2] row_mask:0xf bank_mask:0xf
    v_fmac_f32_dpp v107, v43, v157 quad_perm:[1,0,3,2] row_mask:0xf bank_mask:0xf
    v_mul_f32 v108, v156, v44
    v_mul_f32 v109, v156, v45
    v_fmac_f32_dpp v108, v44, v157 quad_perm:[1,0,3,2] row_mask:0xf bank_mask:0xf
    v_fmac_f32_dpp v109, v45, v157 quad_perm:[1,0,3,2] row_mask:0xf bank_mask:0xf
    v_mul_f32 v110, v156, v46
    v_mul_f32 v111, v156, v47
    v_fmac_f32_dpp v110, v46, v157 quad_perm:[1,0,3,2] row_mask:0xf bank_mask:0xf
    v_fmac_f32_dpp v111, v47, v157 quad_perm:[1,0,3,2] row_mask:0xf bank_mask:0xf
    v_mul_f32 v112, v156, v48
    v_mul_f32 v113, v156, v49
    v_fmac_f32_dpp v112, v48, v157 quad_perm:[1,0,3,2] row_mask:0xf bank_mask:0xf
    v_fmac_f32_dpp v113, v49, v157 quad_perm:[1,0,3,2] row_mask:0xf bank_mask:0xf
    v_mul_f32 v114, v156, v50
    v_mul_f32 v115, v156, v51
    v_fmac_f32_dpp v114, v50, v157 quad_perm:[1,0,3,2] row_mask:0xf bank_mask:0xf
    v_fmac_f32_dpp v115, v51, v157 quad_perm:[1,0,3,2] row_mask:0xf bank_mask:0xf
    v_mul_f32 v116, v156, v52
    v_mul_f32 v117, v156, v53
    v_fmac_f32_dpp v116, v52, v157 quad_perm:[1,0,3,2] row_mask:0xf bank_mask:0xf
    v_fmac_f32_dpp v117, v53, v157 quad_perm:[1,0,3,2] row_mask:0xf bank_mask:0xf
    v_mul_f32 v118, v156, v54
    v_mul_f32 v119, v156, v55
    v_fmac_f32_dpp v118, v54, v157 quad_perm:[1,0,3,2] row_mask:0xf bank_mask:0xf
    v_fmac_f32_dpp v119, v55, v157 quad_perm:[1,0,3,2] row_mask:0xf bank_mask:0xf
    v_mul_f32 v120, v156, v56
    v_mul_f32 v121, v156, v57
    v_fmac_f32_dpp v120, v56, v157 quad_perm:[1,0,3,2] row_mask:0xf bank_mask:0xf
    v_fmac_f32_dpp v121, v57, v157 quad_perm:[1,0,3,2] row_mask:0xf bank_mask:0xf
    v_mul_f32 v122, v156, v58
    v_mul_f32 v123, v156, v59
    v_fmac_f32_dpp v122, v58, v157 quad_perm:[1,0,3,2] row_mask:0xf bank_mask:0xf
    v_fmac_f32_dpp v123, v59, v157 quad_perm:[1,0,3,2] row_mask:0xf bank_mask:0xf
    v_mul_f32 v124, v156, v60
    v_mul_f32 v125, v156, v61
    v_fmac_f32_dpp v124, v60, v157 quad_perm:[1,0,3,2] row_mask:0xf bank_mask:0xf
    v_fmac_f32_dpp v125, v61, v157 quad_perm:[1,0,3,2] row_mask:0xf bank_mask:0xf
    v_mul_f32 v126, v156, v62
    v_mul_f32 v127, v156, v63
    v_fmac_f32_dpp v126, v62, v157 quad_perm:[1,0,3,2] row_mask:0xf bank_mask:0xf
    v_fmac_f32_dpp v127, v63, v157 quad_perm:[1,0,3,2] row_mask:0xf bank_mask:0xf
    s_or_b32 s8, s2, s80
    s_cmp_lg_u32 s8, 0
    s_cbranch_scc1 noep_18
    v_mov_b32 v2, s6
    s_mov_b64 exec, 1
    buffer_store_dword v2, v15, s[52:55], 0 offen
    s_mov_b64 exec, -1
noep_18:
    s_sub_u32 s12, 32, s3
    s_mul_i32 s12, s12, 5120
    s_setprio 3
    s_mov_b32 s15, 0
probe_19:
    buffer_load_dword v2, v83, s[56:59], s12 offen sc1
    s_waitcnt vmcnt(0)
    v_cmp_eq_u32 vcc, -1, v2
    s_nop 0
    s_cbranch_vccz probed_20
    s_sleep 8
    s_add_u32 s15, s15, 1
    s_cmp_lt_u32 s15, 0x10000
    s_cbranch_scc1 probe_19
probed_20:
    s_setprio 3
    s_mov_b32 s8, 5120
    buffer_load_dword v79, v72, s[56:59], s8 offen sc1
    buffer_load_dword v80, v72, s[56:59], 0 offen sc1
    s_mov_b32 s8, 76800
    buffer_load_dword v128, v85, s[56:59], s8 offen sc1
    s_mov_b32 s8, 71680
    buffer_load_dword v129, v85, s[56:59], s8 offen sc1
    s_mov_b32 s8, 66560
    buffer_load_dword v130, v85, s[56:59], s8 offen sc1
    s_mov_b32 s8, 61440
    buffer_load_dword v131, v85, s[56:59], s8 offen sc1
    s_mov_b32 s8, 56320
    buffer_load_dword v132, v85, s[56:59], s8 offen sc1
    s_mov_b32 s8, 51200
    buffer_load_dword v133, v85, s[56:59], s8 offen sc1
    s_mov_b32 s8, 46080
    buffer_load_dword v134, v85, s[56:59], s8 offen sc1
    s_mov_b32 s8, 40960
    buffer_load_dword v135, v85, s[56:59], s8 offen sc1
    s_mov_b32 s8, 35840
    buffer_load_dword v136, v85, s[56:59], s8 offen sc1
    s_mov_b32 s8, 30720
    buffer_load_dword v137, v85, s[56:59], s8 offen sc1
    s_mov_b32 s8, 25600
    buffer_load_dword v138, v85, s[56:59], s8 offen sc1
    s_mov_b32 s8, 20480
    buffer_load_dword v139, v85, s[56:59], s8 offen sc1
    s_mov_b32 s8, 15360
    buffer_load_dword v140, v85, s[56:59], s8 offen sc1
    s_mov_b32 s8, 10240
    buffer_load_dword v141, v85, s[56:59], s8 offen sc1
    s_mov_b32 s8, 5120
    buffer_load_dword v142, v85, s[56:59], s8 offen sc1
    s_mov_b32 s8, 0
    buffer_load_dword v143, v85, s[56:59], s8 offen sc1
    s_waitcnt vmcnt(16)
    v_fma_f32 v81, v28, v79, v80
    v_fmac_f32_dpp v81, v79, v29 quad_perm:[1,0,3,2] row_mask:0xf bank_mask:0xf
    v_mul_f32 v79, v30, v81
    s_nop 0
    v_fmac_f32_dpp v79, v81, v31 quad_perm:[1,0,3,2] row_mask:0xf bank_mask:0xf
    ds_bpermute_b32 v80, v15, v79 offset:240
    s_waitcnt lgkmcnt(0)
    v_add_f32 v79, v79, v80
    ds_bpermute_b32 v80, v15, v79 offset:224
    s_waitcnt lgkmcnt(0)
    v_add_f32 v79, v79, v80
    ds_bpermute_b32 v80, v15, v79 offset:192
    s_waitcnt lgkmcnt(0)
    v_add_f32 v79, v79, v80
    ds_bpermute_b32 v80, v15, v79 offset:128
    s_waitcnt lgkmcnt(0)
    v_add_f32 v79, v79, v80
    v_fma_f32 v80, v64, v79, v78
    s_nop 0
    v_fmac_f32_dpp v80, v79, v65 quad_perm:[1,0,3,2] row_mask:0xf bank_mask:0xf
    v_mul_f32 v79, v66, v80
    s_nop 0
    v_fmac_f32_dpp v79, v80, v67 quad_perm:[1,0,3,2] row_mask:0xf bank_mask:0xf
    v_fmac_f32 v20, v16, v79
    s_nop 0
    v_fmac_f32_dpp v20, v79, v18 quad_perm:[1,0,3,2] row_mask:0xf bank_mask:0xf
    v_fmac_f32 v21, v16, v20
    s_nop 0
    v_fmac_f32_dpp v21, v20, v18 quad_perm:[1,0,3,2] row_mask:0xf bank_mask:0xf
    v_fmac_f32 v22, v16, v21
    s_nop 0
    v_fmac_f32_dpp v22, v21, v18 quad_perm:[1,0,3,2] row_mask:0xf bank_mask:0xf
    v_fmac_f32 v23, v16, v22
    s_nop 0
    v_fmac_f32_dpp v23, v22, v18 quad_perm:[1,0,3,2] row_mask:0xf bank_mask:0xf
    v_cvt_pk_bf16_f32 v79, v20, v21
    v_cvt_pk_bf16_f32 v80, v22, v23
    s_mov_b32 vcc_lo, 0xcccccccc
    s_mov_b32 vcc_hi, 0xcccccccc
    v_cndmask_b32 v81, v80, v79, vcc
    v_cndmask_b32 v82, v79, v80, vcc
    s_add_u32 s13, s69, 8192
    v_mov_b32_dpp v78, v81 quad_perm:[2,3,0,1] row_mask:0xf bank_mask:0xf
    v_perm_b32 v79, v82, v78, v68
    v_perm_b32 v80, v82, v78, v69
    buffer_store_dword v79, v73, s[52:55], s13 offen sc1
    buffer_store_dword v80, v73, s[52:55], s13 offen offset:16 sc1
    s_mov_b32 s94, 0
    s_waitcnt vmcnt(2)
echk_21:
    v_max_u32 v159, v128, v129
    v_max3_u32 v159, v159, v130, v131
    v_max3_u32 v159, v159, v132, v133
    v_max3_u32 v159, v159, v134, v135
    v_max3_u32 v159, v159, v136, v137
    v_max3_u32 v159, v159, v138, v139
    v_max3_u32 v159, v159, v140, v141
    v_max3_u32 v159, v159, v142, v143
    v_cmp_eq_u32 vcc, -1, v159
    s_nop 0
    s_cbranch_vccz eok_22
    s_mov_b32 s8, 76800
    buffer_load_dword v128, v85, s[56:59], s8 offen sc1
    s_mov_b32 s8, 71680
    buffer_load_dword v129, v85, s[56:59], s8 offen sc1
    s_mov_b32 s8, 66560
    buffer_load_dword v130, v85, s[56:59], s8 offen sc1
    s_mov_b32 s8, 61440
    buffer_load_dword v131, v85, s[56:59], s8 offen sc1
    s_mov_b32 s8, 56320
    buffer_load_dword v132, v85, s[56:59], s8 offen sc1
    s_mov_b32 s8, 51200
    buffer_load_dword v133, v85, s[56:59], s8 offen sc1
    s_mov_b32 s8, 46080
    buffer_load_dword v134, v85, s[56:59], s8 offen sc1
    s_mov_b32 s8, 40960
    buffer_load_dword v135, v85, s[56:59], s8 offen sc1
    s_mov_b32 s8, 35840
    buffer_load_dword v136, v85, s[56:59], s8 offen sc1
    s_mov_b32 s8, 30720
    buffer_load_dword v137, v85, s[56:59], s8 offen sc1
    s_mov_b32 s8, 25600
    buffer_load_dword v138, v85, s[56:59], s8 offen sc1
    s_mov_b32 s8, 20480
    buffer_load_dword v139, v85, s[56:59], s8 offen sc1
    s_mov_b32 s8, 15360
    buffer_load_dword v140, v85, s[56:59], s8 offen sc1
    s_mov_b32 s8, 10240
    buffer_load_dword v141, v85, s[56:59], s8 offen sc1
    s_mov_b32 s8, 5120
    buffer_load_dword v142, v85, s[56:59], s8 offen sc1
    s_mov_b32 s8, 0
    buffer_load_dword v143, v85, s[56:59], s8 offen sc1
    s_waitcnt vmcnt(0)
    s_add_u32 s94, s94, 1
    s_cmp_lt_u32 s94, 0x4000
    s_cbranch_scc1 echk_21
eok_22:
    s_lshl_b32 s9, s80, 11
    s_add_u32 s8, s69, s9
    s_add_u32 s9, s8, 73728
    v_fma_f32 v164, v150, v128, v129
    v_fma_f32 v165, v150, v136, v137
    v_fmac_f32_dpp v164, v128, v151 quad_perm:[1,0,3,2] row_mask:0xf bank_mask:0xf
    v_fmac_f32_dpp v165, v136, v151 quad_perm:[1,0,3,2] row_mask:0xf bank_mask:0xf
    v_fma_f32 v162, v150, v164, v130
    v_fma_f32 v163, v150, v165, v138
    v_fmac_f32_dpp v162, v164, v151 quad_perm:[1,0,3,2] row_mask:0xf bank_mask:0xf
    v_fmac_f32_dpp v163, v165, v151 quad_perm:[1,0,3,2] row_mask:0xf bank_mask:0xf
    v_fma_f32 v164, v150, v162, v131
    v_fma_f32 v165, v150, v163, v139
    v_fmac_f32_dpp v164, v162, v151 quad_perm:[1,0,3,2] row_mask:0xf bank_mask:0xf
    v_fmac_f32_dpp v165, v163, v151 quad_perm:[1,0,3,2] row_mask:0xf bank_mask:0xf
    v_fma_f32 v162, v150, v164, v132
    v_fma_f32 v163, v150, v165, v140
    v_fmac_f32_dpp v162, v164, v151 quad_perm:[1,0,3,2] row_mask:0xf bank_mask:0xf
    v_fmac_f32_dpp v163, v165, v151 quad_perm:[1,0,3,2] row_mask:0xf bank_mask:0xf
    v_fma_f32 v164, v150, v162, v133
    v_fma_f32 v165, v150, v163, v141
    v_fmac_f32_dpp v164, v162, v151 quad_perm:[1,0,3,2] row_mask:0xf bank_mask:0xf
    v_fmac_f32_dpp v165, v163, v151 quad_perm:[1,0,3,2] row_mask:0xf bank_mask:0xf
    v_fma_f32 v162, v150, v164, v134
    v_fma_f32 v163, v150, v165, v142
    v_fmac_f32_dpp v162, v164, v151 quad_perm:[1,0,3,2] row_mask:0xf bank_mask:0xf
    v_fmac_f32_dpp v163, v165, v151 quad_perm:[1,0,3,2] row_mask:0xf bank_mask:0xf
    v_fma_f32 v164, v150, v162, v135
    v_fma_f32 v165, v150, v163, v143
    v_fmac_f32_dpp v164, v162, v151 quad_perm:[1,0,3,2] row_mask:0xf bank_mask:0xf
    v_fmac_f32_dpp v165, v163, v151 quad_perm:[1,0,3,2] row_mask:0xf bank_mask:0xf
    v_fma_f32 v159, v152, v164, v165
    v_fmac_f32_dpp v159, v164, v153 quad_perm:[1,0,3,2] row_mask:0xf bank_mask:0xf
    v_mov_b32 v160, v159
    s_nop 1
    v_permlane32_swap_b32 v159, v160
    v_fma_f32 v166, v154, v159, v160
    s_nop 0
    v_fmac_f32_dpp v166, v159, v155 quad_perm:[1,0,3,2] row_mask:0xf bank_mask:0xf
    v_fma_f32 v159, v148, v166, v92
    s_nop 0
    v_fmac_f32_dpp v159, v166, v149 quad_perm:[1,0,3,2] row_mask:0xf bank_mask:0xf
    s_mov_b32 vcc_lo, -1
    s_mov_b32 vcc_hi, 0
    v_cndmask_b32 v159, v159, v166, vcc
    v_fma_f32 v160, v146, v159, v91
    s_nop 0
    v_fmac_f32_dpp v160, v159, v147 quad_perm:[1,0,3,2] row_mask:0xf bank_mask:0xf
    v_mul_f32 v162, v156, v159
    v_fmac_f32_dpp v162, v159, v157 quad_perm:[1,0,3,2] row_mask:0xf bank_mask:0xf
    v_mul_f32 v163, v156, v160
    v_fmac_f32_dpp v163, v160, v157 quad_perm:[1,0,3,2] row_mask:0xf bank_mask:0xf
    v_fmac_f32 v96, v144, v162
    v_fmac_f32 v112, v144, v163
    v_fmac_f32_dpp v96, v162, v158 quad_perm:[1,0,3,2] row_mask:0xf bank_mask:0xf
    v_fmac_f32_dpp v112, v163, v158 quad_perm:[1,0,3,2] row_mask:0xf bank_mask:0xf
    v_fmac_f32 v97, v144, v96
    v_fmac_f32 v113, v144, v112
    v_fmac_f32_dpp v97, v96, v158 quad_perm:[1,0,3,2] row_mask:0xf bank_mask:0xf
    v_fmac_f32_dpp v113, v112, v158 quad_perm:[1,0,3,2] row_mask:0xf bank_mask:0xf
    v_fmac_f32 v98, v144, v97
    v_fmac_f32 v114, v144, v113
    v_fmac_f32_dpp v98, v97, v158 quad_perm:[1,0,3,2] row_mask:0xf bank_mask:0xf
    v_fmac_f32_dpp v114, v113, v158 quad_perm:[1,0,3,2] row_mask:0xf bank_mask:0xf
    v_fmac_f32 v99, v144, v98
    v_fmac_f32 v115, v144, v114
    v_fmac_f32_dpp v99, v98, v158 quad_perm:[1,0,3,2] row_mask:0xf bank_mask:0xf
    v_fmac_f32_dpp v115, v114, v158 quad_perm:[1,0,3,2] row_mask:0xf bank_mask:0xf
    v_fmac_f32 v100, v144, v99
    v_fmac_f32 v116, v144, v115
    v_fmac_f32_dpp v100, v99, v158 quad_perm:[1,0,3,2] row_mask:0xf bank_mask:0xf
    v_fmac_f32_dpp v116, v115, v158 quad_perm:[1,0,3,2] row_mask:0xf bank_mask:0xf
    v_fmac_f32 v101, v144, v100
    v_fmac_f32 v117, v144, v116
    v_fmac_f32_dpp v101, v100, v158 quad_perm:[1,0,3,2] row_mask:0xf bank_mask:0xf
    v_fmac_f32_dpp v117, v116, v158 quad_perm:[1,0,3,2] row_mask:0xf bank_mask:0xf
    v_fmac_f32 v102, v144, v101
    v_fmac_f32 v118, v144, v117
    v_fmac_f32_dpp v102, v101, v158 quad_perm:[1,0,3,2] row_mask:0xf bank_mask:0xf
    v_fmac_f32_dpp v118, v117, v158 quad_perm:[1,0,3,2] row_mask:0xf bank_mask:0xf
    v_fmac_f32 v103, v144, v102
    v_fmac_f32 v119, v144, v118
    v_fmac_f32_dpp v103, v102, v158 quad_perm:[1,0,3,2] row_mask:0xf bank_mask:0xf
    v_fmac_f32_dpp v119, v118, v158 quad_perm:[1,0,3,2] row_mask:0xf bank_mask:0xf
    v_fmac_f32 v104, v144, v103
    v_fmac_f32 v120, v144, v119
    v_fmac_f32_dpp v104, v103, v158 quad_perm:[1,0,3,2] row_mask:0xf bank_mask:0xf
    v_fmac_f32_dpp v120, v119, v158 quad_perm:[1,0,3,2] row_mask:0xf bank_mask:0xf
    v_fmac_f32 v105, v144, v104
    v_fmac_f32 v121, v144, v120
    v_fmac_f32_dpp v105, v104, v158 quad_perm:[1,0,3,2] row_mask:0xf bank_mask:0xf
    v_fmac_f32_dpp v121, v120, v158 quad_perm:[1,0,3,2] row_mask:0xf bank_mask:0xf
    v_fmac_f32 v106, v144, v105
    v_fmac_f32 v122, v144, v121
    v_fmac_f32_dpp v106, v105, v158 quad_perm:[1,0,3,2] row_mask:0xf bank_mask:0xf
    v_fmac_f32_dpp v122, v121, v158 quad_perm:[1,0,3,2] row_mask:0xf bank_mask:0xf
    v_fmac_f32 v107, v144, v106
    v_fmac_f32 v123, v144, v122
    v_fmac_f32_dpp v107, v106, v158 quad_perm:[1,0,3,2] row_mask:0xf bank_mask:0xf
    v_fmac_f32_dpp v123, v122, v158 quad_perm:[1,0,3,2] row_mask:0xf bank_mask:0xf
    v_fmac_f32 v108, v144, v107
    v_fmac_f32 v124, v144, v123
    v_fmac_f32_dpp v108, v107, v158 quad_perm:[1,0,3,2] row_mask:0xf bank_mask:0xf
    v_fmac_f32_dpp v124, v123, v158 quad_perm:[1,0,3,2] row_mask:0xf bank_mask:0xf
    v_fmac_f32 v109, v144, v108
    v_fmac_f32 v125, v144, v124
    v_fmac_f32_dpp v109, v108, v158 quad_perm:[1,0,3,2] row_mask:0xf bank_mask:0xf
    v_fmac_f32_dpp v125, v124, v158 quad_perm:[1,0,3,2] row_mask:0xf bank_mask:0xf
    v_fmac_f32 v110, v144, v109
    v_fmac_f32 v126, v144, v125
    v_fmac_f32_dpp v110, v109, v158 quad_perm:[1,0,3,2] row_mask:0xf bank_mask:0xf
    v_fmac_f32_dpp v126, v125, v158 quad_perm:[1,0,3,2] row_mask:0xf bank_mask:0xf
    v_fmac_f32 v111, v144, v110
    v_fmac_f32 v127, v144, v126
    v_fmac_f32_dpp v111, v110, v158 quad_perm:[1,0,3,2] row_mask:0xf bank_mask:0xf
    v_fmac_f32_dpp v127, v126, v158 quad_perm:[1,0,3,2] row_mask:0xf bank_mask:0xf
    v_cvt_pk_bf16_f32 v128, v96, v97
    v_cvt_pk_bf16_f32 v129, v98, v99
    v_cvt_pk_bf16_f32 v130, v100, v101
    v_cvt_pk_bf16_f32 v131, v102, v103
    ds_write_b128 v86, v[128:131] offset:0
    v_cvt_pk_bf16_f32 v132, v104, v105
    v_cvt_pk_bf16_f32 v133, v106, v107
    v_cvt_pk_bf16_f32 v134, v108, v109
    v_cvt_pk_bf16_f32 v135, v110, v111
    ds_write_b128 v86, v[132:135] offset:16
    v_cvt_pk_bf16_f32 v136, v112, v113
    v_cvt_pk_bf16_f32 v137, v114, v115
    v_cvt_pk_bf16_f32 v138, v116, v117
    v_cvt_pk_bf16_f32 v139, v118, v119
    ds_write_b128 v86, v[136:139] offset:32
    v_cvt_pk_bf16_f32 v140, v120, v121
    v_cvt_pk_bf16_f32 v141, v122, v123
    v_cvt_pk_bf16_f32 v142, v124, v125
    v_cvt_pk_bf16_f32 v143, v126, v127
    ds_write_b128 v86, v[140:143] offset:48
    s_waitcnt lgkmcnt(0)
    ds_read_b64_tr_b16 v[32:33], v87 offset:0
    ds_read_b64_tr_b16 v[34:35], v87 offset:1152
    ds_read_b64_tr_b16 v[36:37], v87 offset:144
    ds_read_b64_tr_b16 v[38:39], v87 offset:1296
    ds_read_b64_tr_b16 v[40:41], v87 offset:2304
    ds_read_b64_tr_b16 v[42:43], v87 offset:3456
    ds_read_b64_tr_b16 v[44:45], v87 offset:2448
    ds_read_b64_tr_b16 v[46:47], v87 offset:3600
    s_waitcnt lgkmcnt(6)
    buffer_store_dwordx4 v[32:35], v161, s[52:55], s8 offen offset:0 sc1
    s_waitcnt lgkmcnt(4)
    buffer_store_dwordx4 v[36:39], v161, s[52:55], s9 offen offset:0 sc1
    s_waitcnt lgkmcnt(2)
    buffer_store_dwordx4 v[40:43], v161, s[52:55], s8 offen offset:1024 sc1
    s_waitcnt lgkmcnt(0)
    buffer_store_dwordx4 v[44:47], v161, s[52:55], s9 offen offset:1024 sc1
    v_mov_b32 v2, s6
    s_waitcnt vmcnt(0)
    s_mov_b32 exec_hi, 0
    buffer_store_dword v2, v15, s[52:55], s68 offen sc1
    s_mov_b32 exec_hi, -1
    s_add_u32 m0, s85, 12288
    s_add_u32 s14, s93, 27648
    buffer_load_dwordx4 v13, s[60:63], s14 offen lds
    s_add_u32 m0, s85, 13312
    s_add_u32 s14, s93, 36864
    buffer_load_dwordx4 v12, s[60:63], s14 offen lds
    s_add_u32 m0, s85, 14336
    s_add_u32 s14, s93, 46080
    buffer_load_dwordx4 v13, s[60:63], s14 offen lds
    s_add_u32 m0, s85, 15360
    s_add_u32 s14, s93, 55296
    buffer_load_dwordx4 v12, s[60:63], s14 offen lds
    s_waitcnt vmcnt(4)
    s_add_u32 m0, s85, 16384
    s_add_u32 s14, s93, 64512
    buffer_load_dwordx4 v13, s[60:63], s14 offen lds
    s_waitcnt vmcnt(4)
    s_add_u32 m0, s85, 17408
    s_add_u32 s14, s93, 73728
    buffer_load_dwordx4 v12, s[60:63], s14 offen lds
    s_waitcnt vmcnt(4)
    s_lshl_b32 s93, s86, 7
    s_add_u32 s93, s93, s84
    s_add_u32 m0, s85, 0
    s_add_u32 s14, s93, 0
    buffer_load_dwordx4 v12, s[60:63], s14 offen lds
    s_waitcnt vmcnt(4)
    s_add_u32 m0, s85, 1024
    s_add_u32 s14, s93, 9216
    buffer_load_dwordx4 v13, s[60:63], s14 offen lds
    s_waitcnt vmcnt(4)
    s_add_u32 m0, s85, 2048
    s_add_u32 s14, s93, 18432
    buffer_load_dwordx4 v12, s[60:63], s14 offen lds
    s_waitcnt vmcnt(4)
    s_add_u32 m0, s85, 3072
    s_add_u32 s14, s93, 27648
    buffer_load_dwordx4 v13, s[60:63], s14 offen lds
    s_waitcnt vmcnt(4)
    s_add_u32 m0, s85, 4096
    s_add_u32 s14, s93, 36864
    buffer_load_dwordx4 v12, s[60:63], s14 offen lds
    s_waitcnt vmcnt(4)
    s_add_u32 m0, s85, 5120
    s_add_u32 s14, s93, 46080
    buffer_load_dwordx4 v13, s[60:63], s14 offen lds
    s_waitcnt vmcnt(4)
    s_add_u32 m0, s85, 6144
    s_add_u32 s14, s93, 55296
    buffer_load_dwordx4 v12, s[60:63], s14 offen lds
    s_waitcnt vmcnt(4)
    s_add_u32 m0, s85, 7168
    s_add_u32 s14, s93, 64512
    buffer_load_dwordx4 v13, s[60:63], s14 offen lds
    s_waitcnt vmcnt(4)
    s_add_u32 m0, s85, 8192
    s_add_u32 s14, s93, 73728
    buffer_load_dwordx4 v12, s[60:63], s14 offen lds
    s_waitcnt vmcnt(4)
    s_sub_u32 s8, s85, 65536
    v_mov_b32 v1, v90
    v_mov_b32 v15, v94
    v_mov_b32 v164, v95
    v_mov_b32 v8, v93
    v_xor_b32 v9, 32, v93
    v_xor_b32 v10, 64, v93
    v_xor_b32 v11, 96, v93
    v_add_u32 v4, s8, v4
    v_add_u32 v5, s8, v5
    v_add_u32 v6, s8, v6
    v_add_u32 v7, s8, v7
    s_mul_i32 s91, s3, 147456
    s_mul_i32 s8, s81, 73728
    s_add_u32 s91, s91, s8
    s_add_u32 s91, s91, 524288
    s_mov_b32 s10, -1
    s_mov_b32 s11, 0
    s_setprio 3
    s_mov_b32 s15, 0
poll_23:
    s_mov_b32 exec_hi, 0
    buffer_load_dword v2, v1, s[52:55], s97 offen sc1
    s_mov_b32 exec_hi, -1
    s_waitcnt vmcnt(0)
    v_cmp_ne_u32 vcc, s6, v2
    s_nop 0
    s_and_b64 vcc, vcc, s[10:11]
    s_cbranch_vccz polld_24
    s_sleep 8
    s_add_u32 s15, s15, 1
    s_cmp_lt_u32 s15, 0x10000
    s_cbranch_scc1 poll_23
polld_24:
    s_setprio 3
    s_lshl_b32 s92, s82, 6
    v_xor_b32 v4, s92, v4
    v_xor_b32 v8, s92, v8
    v_xor_b32 v5, s92, v5
    v_xor_b32 v9, s92, v9
    s_lshl_b32 s94, s86, 13
    s_add_u32 s94, s94, s91
    s_lshl_b32 s9, s82, 12
    s_add_u32 s94, s94, s9
    buffer_load_dwordx4 v[88:91], v15, s[52:55], s94 offen offset:0 sc1
    buffer_load_dwordx4 v[92:95], v15, s[52:55], s94 offen offset:512 sc1
    buffer_load_dwordx4 v[96:99], v15, s[52:55], s94 offen offset:2048 sc1
    buffer_load_dwordx4 v[100:103], v15, s[52:55], s94 offen offset:2560 sc1
    ds_read_b128 v[152:155], v4 offset:0
    ds_read_b128 v[156:159], v4 offset:4096
    ds_read_b128 v[160:163], v8 offset:0
    s_setprio 0
    s_waitcnt vmcnt(2)
    s_waitcnt lgkmcnt(2)
    v_mfma_f32_32x32x16_bf16 v[16:31], v[152:155], v[88:91], 0
    v_mfma_f32_32x32x16_bf16 v[52:67], v[152:155], v[92:95], 0
    ds_read_b128 v[152:155], v5 offset:0
    s_lshl_b32 s94, s87, 13
    s_add_u32 s94, s94, s91
    buffer_load_dwordx4 v[120:123], v15, s[52:55], s94 offen offset:0 sc1
    buffer_load_dwordx4 v[124:127], v15, s[52:55], s94 offen offset:512 sc1
    s_waitcnt lgkmcnt(2)
    v_mfma_f32_32x32x16_bf16 v[32:47], v[156:159], v[88:91], 0
    v_mfma_f32_32x32x16_bf16 v[68:83], v[156:159], v[92:95], 0
    ds_read_b128 v[156:159], v5 offset:4096
    ds_read_b32 v1, v164
    buffer_load_dwordx4 v[128:131], v15, s[52:55], s94 offen offset:2048 sc1
    buffer_load_dwordx4 v[132:135], v15, s[52:55], s94 offen offset:2560 sc1
    s_waitcnt lgkmcnt(3)
    v_mfma_f32_16x16x32_bf16 v[48:51], v[160:163], v[88:91], 0
    s_setprio 3
    v_mfma_f32_16x16x32_bf16 v[84:87], v[160:163], v[92:95], 0
    ds_read_b128 v[160:163], v9 offset:0
    s_add_u32 s94, s94, 4096
    buffer_load_dwordx4 v[136:139], v15, s[52:55], s94 offen offset:0 sc1
    buffer_load_dwordx4 v[140:143], v15, s[52:55], s94 offen offset:512 sc1
    s_waitcnt lgkmcnt(1)
    v_cmp_lt_u32 vcc, 9, v1
    s_nop 0
    s_cbranch_vccnz yp_25
    s_setprio 0
yp_25:
    buffer_load_dwordx4 v[144:147], v15, s[52:55], s94 offen offset:2048 sc1
    buffer_load_dwordx4 v[148:151], v15, s[52:55], s94 offen offset:2560 sc1
    s_waitcnt vmcnt(8)
    v_xor_b32 v4, s92, v4
    v_xor_b32 v8, s92, v8
    v_xor_b32 v5, s92, v5
    v_xor_b32 v9, s92, v9
    v_mfma_f32_32x32x16_bf16 v[16:31], v[152:155], v[96:99], v[16:31]
    v_mfma_f32_32x32x16_bf16 v[52:67], v[152:155], v[100:103], v[52:67]
    ds_read_b128 v[152:155], v4 offset:9216
    v_mfma_f32_32x32x16_bf16 v[32:47], v[156:159], v[96:99], v[32:47]
    v_mfma_f32_32x32x16_bf16 v[68:83], v[156:159], v[100:103], v[68:83]
    ds_read_b128 v[156:159], v4 offset:13312
    ds_read_b32 v1, v164
    s_waitcnt lgkmcnt(3)
    v_mfma_f32_16x16x32_bf16 v[48:51], v[160:163], v[96:99], v[48:51]
    s_setprio 3
    v_mfma_f32_16x16x32_bf16 v[84:87], v[160:163], v[100:103], v[84:87]
    ds_read_b128 v[160:163], v8 offset:9216
    s_waitcnt lgkmcnt(1)
    v_cmp_lt_u32 vcc, 10, v1
    s_nop 0
    s_cbranch_vccnz yp_26
    s_setprio 0
yp_26:
    s_waitcnt vmcnt(6)
    v_mfma_f32_32x32x16_bf16 v[16:31], v[152:155], v[120:123], v[16:31]
    v_mfma_f32_32x32x16_bf16 v[52:67], v[152:155], v[124:127], v[52:67]
    ds_read_b128 v[152:155], v5 offset:9216
    s_lshl_b32 s93, s88, 7
    s_add_u32 s93, s93, s84
    s_add_u32 m0, s85, 0
    s_add_u32 s14, s93, 0
    buffer_load_dwordx4 v12, s[60:63], s14 offen lds
    s_add_u32 m0, s85, 1024
    s_add_u32 s14, s93, 9216
    buffer_load_dwordx4 v13, s[60:63], s14 offen lds
    v_mfma_f32_32x32x16_bf16 v[32:47], v[156:159], v[120:123], v[32:47]
    v_mfma_f32_32x32x16_bf16 v[68:83], v[156:159], v[124:127], v[68:83]
    ds_read_b128 v[156:159], v5 offset:13312
    ds_read_b32 v1, v164
    s_add_u32 m0, s85, 2048
    s_add_u32 s14, s93, 18432
    buffer_load_dwordx4 v12, s[60:63], s14 offen lds
    s_add_u32 m0, s85, 3072
    s_add_u32 s14, s93, 27648
    buffer_load_dwordx4 v13, s[60:63], s14 offen lds
    s_waitcnt lgkmcnt(3)
    v_mfma_f32_16x16x32_bf16 v[48:51], v[160:163], v[120:123], v[48:51]
    s_setprio 3
    v_mfma_f32_16x16x32_bf16 v[84:87], v[160:163], v[124:127], v[84:87]
    ds_read_b128 v[160:163], v9 offset:9216
    s_add_u32 m0, s85, 4096
    s_add_u32 s14, s93, 36864
    buffer_load_dwordx4 v12, s[60:63], s14 offen lds
    s_add_u32 m0, s85, 5120
    s_add_u32 s14, s93, 46080
    buffer_load_dwordx4 v13, s[60:63], s14 offen lds
    s_waitcnt lgkmcnt(1)
    v_cmp_lt_u32 vcc, 10, v1
    s_nop 0
    s_cbranch_vccnz yp_27
    s_setprio 0
yp_27:
    s_waitcnt vmcnt(10)
    v_mfma_f32_32x32x16_bf16 v[16:31], v[152:155], v[128:131], v[16:31]
    v_mfma_f32_32x32x16_bf16 v[52:67], v[152:155], v[132:135], v[52:67]
    ds_read_b128 v[152:155], v6 offset:9216
    s_add_u32 m0, s85, 6144
    s_add_u32 s14, s93, 55296
    buffer_load_dwordx4 v12, s[60:63], s14 offen lds
    s_add_u32 m0, s85, 7168
    s_add_u32 s14, s93, 64512
    buffer_load_dwordx4 v13, s[60:63], s14 offen lds
    v_mfma_f32_32x32x16_bf16 v[32:47], v[156:159], v[128:131], v[32:47]
    v_mfma_f32_32x32x16_bf16 v[68:83], v[156:159], v[132:135], v[68:83]
    ds_read_b128 v[156:159], v6 offset:13312
    ds_read_b32 v1, v164
    s_add_u32 m0, s85, 8192
    s_add_u32 s14, s93, 73728
    buffer_load_dwordx4 v12, s[60:63], s14 offen lds
    s_lshl_b32 s94, s88, 13
    s_add_u32 s94, s94, s91
    buffer_load_dwordx4 v[88:91], v15, s[52:55], s94 offen offset:0 sc1
    s_waitcnt lgkmcnt(3)
    v_mfma_f32_16x16x32_bf16 v[48:51], v[160:163], v[128:131], v[48:51]
    s_setprio 3
    v_mfma_f32_16x16x32_bf16 v[84:87], v[160:163], v[132:135], v[84:87]
    ds_read_b128 v[160:163], v10 offset:9216
    buffer_load_dwordx4 v[92:95], v15, s[52:55], s94 offen offset:512 sc1
    buffer_load_dwordx4 v[96:99], v15, s[52:55], s94 offen offset:2048 sc1
    s_waitcnt lgkmcnt(1)
    v_cmp_lt_u32 vcc, 11, v1
    s_nop 0
    s_cbranch_vccnz yp_28
    s_setprio 0
yp_28:
    s_waitcnt vmcnt(14)
    v_mfma_f32_32x32x16_bf16 v[16:31], v[152:155], v[136:139], v[16:31]
    v_mfma_f32_32x32x16_bf16 v[52:67], v[152:155], v[140:143], v[52:67]
    ds_read_b128 v[152:155], v7 offset:9216
    buffer_load_dwordx4 v[100:103], v15, s[52:55], s94 offen offset:2560 sc1
    s_add_u32 s94, s94, 4096
    buffer_load_dwordx4 v[104:107], v15, s[52:55], s94 offen offset:0 sc1
    v_mfma_f32_32x32x16_bf16 v[32:47], v[156:159], v[136:139], v[32:47]
    v_mfma_f32_32x32x16_bf16 v[68:83], v[156:159], v[140:143], v[68:83]
    ds_read_b128 v[156:159], v7 offset:13312
    ds_read_b32 v1, v164
    buffer_load_dwordx4 v[108:111], v15, s[52:55], s94 offen offset:512 sc1
    buffer_load_dwordx4 v[112:115], v15, s[52:55], s94 offen offset:2048 sc1
    s_waitcnt lgkmcnt(3)
    v_mfma_f32_16x16x32_bf16 v[48:51], v[160:163], v[136:139], v[48:51]
    s_setprio 3
    v_mfma_f32_16x16x32_bf16 v[84:87], v[160:163], v[140:143], v[84:87]
    ds_read_b128 v[160:163], v11 offset:9216
    buffer_load_dwordx4 v[116:119], v15, s[52:55], s94 offen offset:2560 sc1
    s_waitcnt lgkmcnt(1)
    v_cmp_lt_u32 vcc, 11, v1
    s_nop 0
    s_cbranch_vccnz yp_29
    s_setprio 0
yp_29:
    s_waitcnt vmcnt(17)
    s_waitcnt vmcnt(8)
    v_mfma_f32_32x32x16_bf16 v[16:31], v[152:155], v[144:147], v[16:31]
    v_mfma_f32_32x32x16_bf16 v[52:67], v[152:155], v[148:151], v[52:67]
    ds_read_b128 v[152:155], v4 offset:0
    v_mfma_f32_32x32x16_bf16 v[32:47], v[156:159], v[144:147], v[32:47]
    v_mfma_f32_32x32x16_bf16 v[68:83], v[156:159], v[148:151], v[68:83]
    ds_read_b128 v[156:159], v4 offset:4096
    ds_read_b32 v1, v164
    s_waitcnt lgkmcnt(3)
    v_mfma_f32_16x16x32_bf16 v[48:51], v[160:163], v[144:147], v[48:51]
    s_setprio 3
    v_mfma_f32_16x16x32_bf16 v[84:87], v[160:163], v[148:151], v[84:87]
    ds_read_b128 v[160:163], v8 offset:0
    s_waitcnt lgkmcnt(1)
    v_cmp_lt_u32 vcc, 12, v1
    s_nop 0
    s_cbranch_vccnz yp_30
    s_setprio 0
yp_30:
    s_waitcnt vmcnt(6)
    v_mfma_f32_32x32x16_bf16 v[16:31], v[152:155], v[88:91], v[16:31]
    v_mfma_f32_32x32x16_bf16 v[52:67], v[152:155], v[92:95], v[52:67]
    ds_read_b128 v[152:155], v5 offset:0
    s_lshl_b32 s93, s89, 7
    s_add_u32 s93, s93, s84
    s_add_u32 m0, s85, 9216
    s_add_u32 s14, s93, 0
    buffer_load_dwordx4 v12, s[60:63], s14 offen lds
    s_add_u32 m0, s85, 10240
    s_add_u32 s14, s93, 9216
    buffer_load_dwordx4 v13, s[60:63], s14 offen lds
    v_mfma_f32_32x32x16_bf16 v[32:47], v[156:159], v[88:91], v[32:47]
    v_mfma_f32_32x32x16_bf16 v[68:83], v[156:159], v[92:95], v[68:83]
    ds_read_b128 v[156:159], v5 offset:4096
    ds_read_b32 v1, v164
    s_add_u32 m0, s85, 11264
    s_add_u32 s14, s93, 18432
    buffer_load_dwordx4 v12, s[60:63], s14 offen lds
    s_add_u32 m0, s85, 12288
    s_add_u32 s14, s93, 27648
    buffer_load_dwordx4 v13, s[60:63], s14 offen lds
    s_waitcnt lgkmcnt(3)
    v_mfma_f32_16x16x32_bf16 v[48:51], v[160:163], v[88:91], v[48:51]
    s_setprio 3
    v_mfma_f32_16x16x32_bf16 v[84:87], v[160:163], v[92:95], v[84:87]
    ds_read_b128 v[160:163], v9 offset:0
    s_add_u32 m0, s85, 13312
    s_add_u32 s14, s93, 36864
    buffer_load_dwordx4 v12, s[60:63], s14 offen lds
    s_add_u32 m0, s85, 14336
    s_add_u32 s14, s93, 46080
    buffer_load_dwordx4 v13, s[60:63], s14 offen lds
    s_waitcnt lgkmcnt(1)
    v_cmp_lt_u32 vcc, 12, v1
    s_nop 0
    s_cbranch_vccnz yp_31
    s_setprio 0
yp_31:
    s_waitcnt vmcnt(10)
    v_mfma_f32_32x32x16_bf16 v[16:31], v[152:155], v[96:99], v[16:31]
    v_mfma_f32_32x32x16_bf16 v[52:67], v[152:155], v[100:103], v[52:67]
    ds_read_b128 v[152:155], v6 offset:0
    s_add_u32 m0, s85, 15360
    s_add_u32 s14, s93, 55296
    buffer_load_dwordx4 v12, s[60:63], s14 offen lds
    s_add_u32 m0, s85, 16384
    s_add_u32 s14, s93, 64512
    buffer_load_dwordx4 v13, s[60:63], s14 offen lds
    v_mfma_f32_32x32x16_bf16 v[32:47], v[156:159], v[96:99], v[32:47]
    v_mfma_f32_32x32x16_bf16 v[68:83], v[156:159], v[100:103], v[68:83]
    ds_read_b128 v[156:159], v6 offset:4096
    ds_read_b32 v1, v164
    s_add_u32 m0, s85, 17408
    s_add_u32 s14, s93, 73728
    buffer_load_dwordx4 v12, s[60:63], s14 offen lds
    s_lshl_b32 s94, s89, 13
    s_add_u32 s94, s94, s91
    buffer_load_dwordx4 v[120:123], v15, s[52:55], s94 offen offset:0 sc1
    s_waitcnt lgkmcnt(3)
    v_mfma_f32_16x16x32_bf16 v[48:51], v[160:163], v[96:99], v[48:51]
    s_setprio 3
    v_mfma_f32_16x16x32_bf16 v[84:87], v[160:163], v[100:103], v[84:87]
    ds_read_b128 v[160:163], v10 offset:0
    buffer_load_dwordx4 v[124:127], v15, s[52:55], s94 offen offset:512 sc1
    buffer_load_dwordx4 v[128:131], v15, s[52:55], s94 offen offset:2048 sc1
    s_waitcnt lgkmcnt(1)
    v_cmp_lt_u32 vcc, 13, v1
    s_nop 0
    s_cbranch_vccnz yp_32
    s_setprio 0
yp_32:
    s_waitcnt vmcnt(14)
    v_mfma_f32_32x32x16_bf16 v[16:31], v[152:155], v[104:107], v[16:31]
    v_mfma_f32_32x32x16_bf16 v[52:67], v[152:155], v[108:111], v[52:67]
    ds_read_b128 v[152:155], v7 offset:0
    buffer_load_dwordx4 v[132:135], v15, s[52:55], s94 offen offset:2560 sc1
    s_add_u32 s94, s94, 4096
    buffer_load_dwordx4 v[136:139], v15, s[52:55], s94 offen offset:0 sc1
    v_mfma_f32_32x32x16_bf16 v[32:47], v[156:159], v[104:107], v[32:47]
    v_mfma_f32_32x32x16_bf16 v[68:83], v[156:159], v[108:111], v[68:83]
    ds_read_b128 v[156:159], v7 offset:4096
    ds_read_b32 v1, v164
    buffer_load_dwordx4 v[140:143], v15, s[52:55], s94 offen offset:512 sc1
    buffer_load_dwordx4 v[144:147], v15, s[52:55], s94 offen offset:2048 sc1
    s_waitcnt lgkmcnt(3)
    v_mfma_f32_16x16x32_bf16 v[48:51], v[160:163], v[104:107], v[48:51]
    s_setprio 3
    v_mfma_f32_16x16x32_bf16 v[84:87], v[160:163], v[108:111], v[84:87]
    ds_read_b128 v[160:163], v11 offset:0
    buffer_load_dwordx4 v[148:151], v15, s[52:55], s94 offen offset:2560 sc1
    s_waitcnt lgkmcnt(1)
    v_cmp_lt_u32 vcc, 13, v1
    s_nop 0
    s_cbranch_vccnz yp_33
    s_setprio 0
yp_33:
    s_waitcnt vmcnt(17)
    s_waitcnt vmcnt(8)
    v_mfma_f32_32x32x16_bf16 v[16:31], v[152:155], v[112:115], v[16:31]
    v_mfma_f32_32x32x16_bf16 v[52:67], v[152:155], v[116:119], v[52:67]
    v_mfma_f32_32x32x16_bf16 v[32:47], v[156:159], v[112:115], v[32:47]
    v_mfma_f32_32x32x16_bf16 v[68:83], v[156:159], v[116:119], v[68:83]
    s_waitcnt lgkmcnt(0)
    v_mfma_f32_16x16x32_bf16 v[48:51], v[160:163], v[112:115], v[48:51]
    s_setprio 3
    v_mfma_f32_16x16x32_bf16 v[84:87], v[160:163], v[116:119], v[84:87]
    s_lshl_b32 s93, s90, 7
    s_add_u32 s93, s93, s84
    s_add_u32 m0, s85, 0
    s_add_u32 s14, s93, 0
    buffer_load_dwordx4 v12, s[60:63], s14 offen lds
    s_waitcnt vmcnt(5)
    s_add_u32 m0, s85, 1024
    s_add_u32 s14, s93, 9216
    buffer_load_dwordx4 v13, s[60:63], s14 offen lds
    s_waitcnt vmcnt(5)
    s_add_u32 m0, s85, 2048
    s_add_u32 s14, s93, 18432
    buffer_load_dwordx4 v12, s[60:63], s14 offen lds
    s_waitcnt vmcnt(5)
    s_add_u32 m0, s85, 3072
    s_add_u32 s14, s93, 27648
    buffer_load_dwordx4 v13, s[60:63], s14 offen lds
    s_waitcnt vmcnt(5)
    s_add_u32 m0, s85, 4096
    s_add_u32 s14, s93, 36864
    buffer_load_dwordx4 v12, s[60:63], s14 offen lds
    s_waitcnt vmcnt(5)
    s_add_u32 m0, s85, 5120
    s_add_u32 s14, s93, 46080
    buffer_load_dwordx4 v13, s[60:63], s14 offen lds
    s_waitcnt vmcnt(5)
    s_add_u32 m0, s85, 6144
    s_add_u32 s14, s93, 55296
    buffer_load_dwordx4 v12, s[60:63], s14 offen lds
    s_waitcnt vmcnt(5)
    s_add_u32 m0, s85, 7168
    s_add_u32 s14, s93, 64512
    buffer_load_dwordx4 v13, s[60:63], s14 offen lds
    s_waitcnt vmcnt(5)
    s_add_u32 m0, s85, 8192
    s_add_u32 s14, s93, 73728
    buffer_load_dwordx4 v12, s[60:63], s14 offen lds
    s_waitcnt vmcnt(5)
    s_lshl_b32 s94, s90, 13
    s_add_u32 s94, s94, s91
    buffer_load_dwordx4 v[88:91], v15, s[52:55], s94 offen offset:0 sc1
    s_waitcnt vmcnt(5)
    buffer_load_dwordx4 v[92:95], v15, s[52:55], s94 offen offset:512 sc1
    s_waitcnt vmcnt(5)
    buffer_load_dwordx4 v[96:99], v15, s[52:55], s94 offen offset:2048 sc1
    s_waitcnt vmcnt(5)
    buffer_load_dwordx4 v[100:103], v15, s[52:55], s94 offen offset:2560 sc1
    s_waitcnt vmcnt(5)
    s_add_u32 s94, s94, 4096
    buffer_load_dwordx4 v[104:107], v15, s[52:55], s94 offen offset:0 sc1
    s_waitcnt vmcnt(5)
    buffer_load_dwordx4 v[108:111], v15, s[52:55], s94 offen offset:512 sc1
    s_waitcnt vmcnt(5)
    buffer_load_dwordx4 v[112:115], v15, s[52:55], s94 offen offset:2048 sc1
    s_waitcnt vmcnt(5)
    buffer_load_dwordx4 v[116:119], v15, s[52:55], s94 offen offset:2560 sc1
    s_waitcnt vmcnt(5)
    s_mul_i32 s8, s80, 82944
    s_mul_i32 s9, s4, 144
    s_add_u32 s8, s8, s9
    s_mul_i32 s9, s80, 10368
    s_mov_b32 exec_hi, 4194303
    s_add_u32 m0, s9, 115200
    s_add_u32 s14, s8, 331776
    buffer_load_dwordx4 v14, s[64:67], s14 offen lds
    s_waitcnt vmcnt(5)
    s_add_u32 m0, s9, 116064
    s_add_u32 s14, s8, 338688
    buffer_load_dwordx4 v14, s[64:67], s14 offen lds
    s_waitcnt vmcnt(5)
    s_add_u32 m0, s9, 116928
    s_add_u32 s14, s8, 345600
    buffer_load_dwordx4 v14, s[64:67], s14 offen lds
    s_waitcnt vmcnt(5)
    s_add_u32 m0, s9, 117792
    s_add_u32 s14, s8, 352512
    buffer_load_dwordx4 v14, s[64:67], s14 offen lds
    s_waitcnt vmcnt(5)
    s_add_u32 m0, s9, 118656
    s_add_u32 s14, s8, 359424
    buffer_load_dwordx4 v14, s[64:67], s14 offen lds
    s_waitcnt vmcnt(5)
    s_add_u32 m0, s9, 119520
    s_add_u32 s14, s8, 366336
    buffer_load_dwordx4 v14, s[64:67], s14 offen lds
    s_waitcnt vmcnt(5)
    s_add_u32 m0, s9, 120384
    s_add_u32 s14, s8, 373248
    buffer_load_dwordx4 v14, s[64:67], s14 offen lds
    s_waitcnt vmcnt(5)
    s_add_u32 m0, s9, 121248
    s_add_u32 s14, s8, 380160
    buffer_load_dwordx4 v14, s[64:67], s14 offen lds
    s_waitcnt vmcnt(5)
    s_add_u32 m0, s9, 122112
    s_add_u32 s14, s8, 387072
    buffer_load_dwordx4 v14, s[64:67], s14 offen lds
    s_waitcnt vmcnt(5)
    s_add_u32 m0, s9, 122976
    s_add_u32 s14, s8, 393984
    buffer_load_dwordx4 v14, s[64:67], s14 offen lds
    s_waitcnt vmcnt(5)
    s_add_u32 m0, s9, 123840
    s_add_u32 s14, s8, 400896
    buffer_load_dwordx4 v14, s[64:67], s14 offen lds
    s_waitcnt vmcnt(5)
    s_add_u32 m0, s9, 124704
    s_add_u32 s14, s8, 407808
    buffer_load_dwordx4 v14, s[64:67], s14 offen lds
    s_waitcnt vmcnt(5)
    s_mov_b32 exec_hi, -1
    s_setprio 0
    s_setprio 3
    s_mul_i32 s13, s3, 73728
    s_lshl_b32 s9, s80, 11
    s_add_u32 s95, s13, s9
    s_add_u32 s95, s95, 5308416
    s_lshl_b32 s9, s80, 14
    s_add_u32 s13, s13, s9
    s_add_u32 s13, s13, 5242880
    s_add_u32 s12, s13, 1532
    v_and_b32 v152, 1, v0
    v_lshrrev_b32 v154, 1, v0
    v_lshlrev_b32 v154, 11, v154
    v_lshl_add_u32 v154, v152, 9, v154
    v_lshrrev_b32 v152, 4, v0
    v_lshl_add_u32 v3, v152, 28, v154
    v_bfe_u32 v152, v0, 2, 2
    v_lshrrev_b32 v153, 5, v0
    v_lshlrev_b32 v154, 1, v153
    v_lshl_add_u32 v154, v152, 2, v154
    v_mul_u32_u24 v12, 144, v154
    v_lshrrev_b32 v154, 1, v152
    v_lshl_add_u32 v154, v153, 2, v154
    v_mul_u32_u24 v154, 18, v154
    v_and_b32 v152, 1, v152
    v_add3_u32 v154, v154, v152, 16
    v_mul_u32_u24 v165, 144, v154
    v_and_b32 v152, 3, v0
    v_bfe_u32 v155, v0, 4, 1
    v_lshl_add_u32 v154, v155, 2, v152
    v_lshlrev_b32 v154, 3, v154
    v_lshrrev_b32 v1, 1, v152
    v_xor_b32 v1, v1, v155
    v_lshlrev_b32 v1, 18, v1
    v_and_b32 v152, 1, v152
    v_lshl_add_u32 v1, v152, 3, v1
    v_add_u32 v1, 128, v1
    s_mul_i32 s9, s80, 20736
    s_add_u32 s9, s9, 73728
    v_add3_u32 v13, v12, v1, s9
    v_add3_u32 v12, v12, v154, s9
    v_add3_u32 v166, v165, v1, s9
    v_add3_u32 v165, v165, v154, s9
    s_lshl_b32 s9, s80, 2
    s_add_u32 s9, s9, 162624
    v_lshl_add_u32 v2, v0, 18, s9
    s_mov_b32 s94, 0
    s_setprio 3
    ds_read_b128 v[152:155], v4 offset:9216
    ds_read_b128 v[156:159], v4 offset:13312
    ds_read_b128 v[160:163], v8 offset:9216
    s_mov_b32 s15, 0
lw_34:
    ds_read_b32 v1, v164 offset:0
    s_waitcnt lgkmcnt(0)
    v_cmp_gt_u32 vcc, 14, v1
    s_nop 0
    s_cbranch_vccz lwd_35
    s_sleep 4
    s_add_u32 s15, s15, 1
    s_cmp_lt_u32 s15, 0x100000
    s_cbranch_scc1 lw_34
lwd_35:
    s_mul_i32 s8, s80, 18432
    s_mul_i32 s9, s4, 144
    s_add_u32 s8, s8, s9
    s_mul_i32 s9, s80, 2304
    s_mov_b32 exec_hi, 15
    s_add_u32 m0, s9, 73728
    s_add_u32 s14, s8, 0
    buffer_load_dwordx4 v14, s[64:67], s14 offen lds
    s_add_u32 m0, s9, 74304
    s_add_u32 s14, s8, 4608
    buffer_load_dwordx4 v14, s[64:67], s14 offen lds
    s_add_u32 m0, s9, 74880
    s_add_u32 s14, s8, 9216
    buffer_load_dwordx4 v14, s[64:67], s14 offen lds
    s_add_u32 m0, s9, 75456
    s_add_u32 s14, s8, 13824
    buffer_load_dwordx4 v14, s[64:67], s14 offen lds
    s_mov_b32 exec_hi, -1
    s_mov_b32 s15, 0
lw_36:
    ds_read_b32 v1, v164 offset:0
    s_waitcnt lgkmcnt(0)
    v_cmp_gt_u32 vcc, 15, v1
    s_nop 0
    s_cbranch_vccz lwd_37
    s_sleep 4
    s_add_u32 s15, s15, 1
    s_cmp_lt_u32 s15, 0x100000
    s_cbranch_scc1 lw_36
lwd_37:
    s_mul_i32 s8, s80, 18432
    s_mul_i32 s9, s4, 144
    s_add_u32 s8, s8, s9
    s_mul_i32 s9, s80, 2304
    s_mov_b32 exec_hi, 15
    s_add_u32 m0, s9, 82944
    s_add_u32 s14, s8, 73728
    buffer_load_dwordx4 v14, s[64:67], s14 offen lds
    s_add_u32 m0, s9, 83520
    s_add_u32 s14, s8, 78336
    buffer_load_dwordx4 v14, s[64:67], s14 offen lds
    s_add_u32 m0, s9, 84096
    s_add_u32 s14, s8, 82944
    buffer_load_dwordx4 v14, s[64:67], s14 offen lds
    s_add_u32 m0, s9, 84672
    s_add_u32 s14, s8, 87552
    buffer_load_dwordx4 v14, s[64:67], s14 offen lds
    s_mov_b32 exec_hi, -1
    s_mov_b32 s15, 0
lw_38:
    ds_read_b32 v1, v164 offset:0
    s_waitcnt lgkmcnt(0)
    v_cmp_gt_u32 vcc, 16, v1
    s_nop 0
    s_cbranch_vccz lwd_39
    s_sleep 4
    s_add_u32 s15, s15, 1
    s_cmp_lt_u32 s15, 0x100000
    s_cbranch_scc1 lw_38
lwd_39:
    s_mul_i32 s8, s80, 18432
    s_mul_i32 s9, s4, 144
    s_add_u32 s8, s8, s9
    s_mul_i32 s9, s80, 2304
    s_mov_b32 exec_hi, 15
    s_add_u32 m0, s9, 92160
    s_add_u32 s14, s8, 147456
    buffer_load_dwordx4 v14, s[64:67], s14 offen lds
    s_add_u32 m0, s9, 92736
    s_add_u32 s14, s8, 152064
    buffer_load_dwordx4 v14, s[64:67], s14 offen lds
    s_add_u32 m0, s9, 93312
    s_add_u32 s14, s8, 156672
    buffer_load_dwordx4 v14, s[64:67], s14 offen lds
    s_add_u32 m0, s9, 93888
    s_add_u32 s14, s8, 161280
    buffer_load_dwordx4 v14, s[64:67], s14 offen lds
    s_mov_b32 exec_hi, -1
    s_waitcnt vmcnt(0)
    s_mov_b32 s15, 0
lw_40:
    ds_read_b32 v1, v164 offset:0
    s_waitcnt lgkmcnt(0)
    v_cmp_gt_u32 vcc, 17, v1
    s_nop 0
    s_cbranch_vccz lwd_41
    s_sleep 1
    s_add_u32 s15, s15, 1
    s_cmp_lt_u32 s15, 0x100000
    s_cbranch_scc1 lw_40
lwd_41:
    s_setprio 3
    v_mfma_f32_32x32x16_bf16 v[16:31], v[152:155], v[120:123], v[16:31]
    v_mfma_f32_32x32x16_bf16 v[52:67], v[152:155], v[124:127], v[52:67]
    ds_read_b128 v[152:155], v5 offset:9216
    s_mul_i32 s8, s80, 32256
    s_mul_i32 s9, s4, 144
    s_add_u32 s8, s8, s9
    s_mul_i32 s9, s80, 4032
    s_mov_b32 exec_hi, -1
    s_add_u32 m0, s9, 101376
    s_add_u32 s14, s8, 221184
    buffer_load_dwordx4 v14, s[64:67], s14 offen lds
    v_mfma_f32_32x32x16_bf16 v[32:47], v[156:159], v[120:123], v[32:47]
    v_mfma_f32_32x32x16_bf16 v[68:83], v[156:159], v[124:127], v[68:83]
    ds_read_b128 v[156:159], v5 offset:13312
    s_add_u32 m0, s9, 102384
    s_add_u32 s14, s8, 229248
    buffer_load_dwordx4 v14, s[64:67], s14 offen lds
    v_mfma_f32_16x16x32_bf16 v[48:51], v[160:163], v[120:123], v[48:51]
    v_mfma_f32_16x16x32_bf16 v[84:87], v[160:163], v[124:127], v[84:87]
    ds_read_b128 v[160:163], v9 offset:9216
    s_add_u32 m0, s9, 103392
    s_add_u32 s14, s8, 237312
    buffer_load_dwordx4 v14, s[64:67], s14 offen lds
    s_waitcnt lgkmcnt(2)
    v_mfma_f32_32x32x16_bf16 v[16:31], v[152:155], v[128:131], v[16:31]
    v_mfma_f32_32x32x16_bf16 v[52:67], v[152:155], v[132:135], v[52:67]
    ds_read_b128 v[152:155], v6 offset:9216
    s_add_u32 m0, s9, 104400
    s_add_u32 s14, s8, 245376
    buffer_load_dwordx4 v14, s[64:67], s14 offen lds
    s_mov_b32 exec_hi, -1
    s_waitcnt lgkmcnt(2)
    v_mfma_f32_32x32x16_bf16 v[32:47], v[156:159], v[128:131], v[32:47]
    v_mfma_f32_32x32x16_bf16 v[68:83], v[156:159], v[132:135], v[68:83]
    ds_read_b128 v[156:159], v6 offset:13312
    s_waitcnt lgkmcnt(2)
    v_mfma_f32_16x16x32_bf16 v[48:51], v[160:163], v[128:131], v[48:51]
    v_mfma_f32_16x16x32_bf16 v[84:87], v[160:163], v[132:135], v[84:87]
    ds_read_b128 v[160:163], v10 offset:9216
    s_add_u32 s93, s13, 8192
    s_mov_b32 s92, 10368
    s_waitcnt lgkmcnt(2)
    v_mfma_f32_32x32x16_bf16 v[16:31], v[152:155], v[136:139], v[16:31]
    ds_read_b128 v[120:123], v7 offset:9216
    v_mfma_f32_32x32x16_bf16 v[52:67], v[152:155], v[140:143], v[52:67]
    ds_read_b128 v[124:127], v7 offset:13312
    s_waitcnt lgkmcnt(2)
    v_mfma_f32_32x32x16_bf16 v[32:47], v[156:159], v[136:139], v[32:47]
    ds_read_b128 v[128:131], v11 offset:9216
    v_mfma_f32_32x32x16_bf16 v[68:83], v[156:159], v[140:143], v[68:83]
    v_lshrrev_b32 v133, 5, v0
    v_and_b32 v132, 31, v0
    v_mul_u32_u24 v132, 288, v132
    v_mfma_f32_16x16x32_bf16 v[48:51], v[160:163], v[136:139], v[48:51]
    v_mfma_f32_16x16x32_bf16 v[84:87], v[160:163], v[140:143], v[84:87]
    s_waitcnt lgkmcnt(2)
    v_mfma_f32_32x32x16_bf16 v[16:31], v[120:123], v[144:147], v[16:31]
    ds_read_b128 v[152:155], v4 offset:0
    v_mfma_f32_32x32x16_bf16 v[52:67], v[120:123], v[148:151], v[52:67]
    ds_read_b128 v[156:159], v4 offset:4096
    s_waitcnt lgkmcnt(2)
    v_mfma_f32_32x32x16_bf16 v[32:47], v[124:127], v[144:147], v[32:47]
    ds_read_b128 v[160:163], v8 offset:0
    v_mfma_f32_32x32x16_bf16 v[68:83], v[124:127], v[148:151], v[68:83]
    v_lshl_add_u32 v132, v133, 4, v132
    v_add_u32 v14, s85, v132
    v_and_b32 v132, 15, v0
    v_mfma_f32_16x16x32_bf16 v[48:51], v[128:131], v[144:147], v[48:51]
    v_mfma_f32_16x16x32_bf16 v[84:87], v[128:131], v[148:151], v[84:87]
    s_waitcnt lgkmcnt(2)
    v_mfma_f32_32x32x16_bf16 v[16:31], v[152:155], v[88:91], v[16:31]
    ds_read_b128 v[120:123], v5 offset:0
    buffer_load_dwordx4 v[136:139], v15, s[52:55], s13 offen offset:0 sc1
    v_mfma_f32_32x32x16_bf16 v[52:67], v[152:155], v[92:95], v[52:67]
    ds_read_b128 v[124:127], v5 offset:4096
    buffer_load_dwordx4 v[140:143], v15, s[52:55], s13 offen offset:512 sc1
    s_waitcnt lgkmcnt(2)
    v_mfma_f32_32x32x16_bf16 v[32:47], v[156:159], v[88:91], v[32:47]
    ds_read_b128 v[128:131], v9 offset:0
    buffer_load_dwordx4 v[144:147], v15, s[52:55], s13 offen offset:2048 sc1
    s_waitcnt vmcnt(3)
    ds_write_b32 v2, v2
    v_mfma_f32_32x32x16_bf16 v[68:83], v[156:159], v[92:95], v[68:83]
    buffer_load_dwordx4 v[148:151], v15, s[52:55], s13 offen offset:2560 sc1
    v_mfma_f32_16x16x32_bf16 v[48:51], v[160:163], v[88:91], v[48:51]
    v_mfma_f32_16x16x32_bf16 v[84:87], v[160:163], v[92:95], v[84:87]
    s_waitcnt lgkmcnt(3)
    v_mfma_f32_32x32x16_bf16 v[16:31], v[120:123], v[96:99], v[16:31]
    ds_read_b128 v[152:155], v6 offset:0
    s_add_u32 s8, s13, 4096
    buffer_load_dwordx4 v[88:91], v15, s[52:55], s8 offen offset:0 sc1
    v_mfma_f32_32x32x16_bf16 v[52:67], v[120:123], v[100:103], v[52:67]
    ds_read_b128 v[156:159], v6 offset:4096
    buffer_load_dwordx4 v[92:95], v15, s[52:55], s8 offen offset:512 sc1
    s_waitcnt lgkmcnt(3)
    v_mfma_f32_32x32x16_bf16 v[32:47], v[124:127], v[96:99], v[32:47]
    ds_read_b128 v[160:163], v10 offset:0
    v_mfma_f32_32x32x16_bf16 v[68:83], v[124:127], v[100:103], v[68:83]
    ds_read_b32 v1, v164 offset:64
    v_mfma_f32_16x16x32_bf16 v[48:51], v[128:131], v[96:99], v[48:51]
    v_mfma_f32_16x16x32_bf16 v[84:87], v[128:131], v[100:103], v[84:87]
    s_waitcnt lgkmcnt(3)
    v_mfma_f32_32x32x16_bf16 v[16:31], v[152:155], v[104:107], v[16:31]
    ds_read_b128 v[120:123], v7 offset:0
    s_add_u32 s8, s13, 4096
    buffer_load_dwordx4 v[96:99], v15, s[52:55], s8 offen offset:2048 sc1
    v_mfma_f32_32x32x16_bf16 v[52:67], v[152:155], v[108:111], v[52:67]
    ds_read_b128 v[124:127], v7 offset:4096
    buffer_load_dwordx4 v[100:103], v15, s[52:55], s8 offen offset:2560 sc1
    s_waitcnt lgkmcnt(3)
    s_waitcnt lgkmcnt(2)
    v_cmp_gt_u32 vcc, 4, v1
    v_mfma_f32_32x32x16_bf16 v[32:47], v[156:159], v[104:107], v[32:47]
    s_cbranch_vccnz wosync_42
wosync_42_r:
    ds_read_b128 v[128:131], v11 offset:0
    v_mfma_f32_32x32x16_bf16 v[68:83], v[156:159], v[108:111], v[68:83]
    v_mfma_f32_16x16x32_bf16 v[48:51], v[160:163], v[104:107], v[48:51]
    v_mfma_f32_16x16x32_bf16 v[84:87], v[160:163], v[108:111], v[84:87]
    s_waitcnt lgkmcnt(2)
    v_mfma_f32_32x32x16_bf16 v[16:31], v[120:123], v[112:115], v[16:31]
    ds_read_b64_tr_b16 v[152:153], v12 offset:0
    ds_read_b64_tr_b16 v[154:155], v12 offset:144
    v_mfma_f32_32x32x16_bf16 v[52:67], v[120:123], v[116:119], v[52:67]
    ds_read_b64_tr_b16 v[156:157], v12 offset:64
    ds_read_b64_tr_b16 v[158:159], v12 offset:208
    s_waitcnt lgkmcnt(4)
    v_mfma_f32_32x32x16_bf16 v[32:47], v[124:127], v[112:115], v[32:47]
    ds_read_b64_tr_b16 v[160:161], v13 offset:0
    ds_read_b64_tr_b16 v[162:163], v13 offset:144
    s_waitcnt vmcnt(6)
    v_max_u32 v2, v139, v143
    v_mfma_f32_32x32x16_bf16 v[68:83], v[124:127], v[116:119], v[68:83]
    v_cmp_eq_u32 vcc, -1, v2
    buffer_load_dwordx4 v[104:107], v15, s[52:55], s93 offen offset:0 sc1
    buffer_load_dwordx4 v[108:111], v15, s[52:55], s93 offen offset:512 sc1
    v_mfma_f32_16x16x32_bf16 v[48:51], v[128:131], v[112:115], v[48:51]
    s_cbranch_vccnz oslow_43
oslow_43_r:
    v_mfma_f32_16x16x32_bf16 v[84:87], v[128:131], v[116:119], v[84:87]
    s_waitcnt lgkmcnt(4)
    v_mfma_f32_32x32x16_bf16 v[16:31], v[152:155], v[136:139], v[16:31]
    ds_read_b64_tr_b16 v[120:121], v12 offset:2592
    ds_read_b64_tr_b16 v[122:123], v12 offset:2736
    v_mfma_f32_32x32x16_bf16 v[52:67], v[152:155], v[140:143], v[52:67]
    ds_read_b64_tr_b16 v[124:125], v12 offset:2656
    ds_read_b64_tr_b16 v[126:127], v12 offset:2800
    s_waitcnt lgkmcnt(4)
    v_mfma_f32_32x32x16_bf16 v[32:47], v[156:159], v[136:139], v[32:47]
    ds_read_b64_tr_b16 v[128:129], v13 offset:2592
    ds_read_b64_tr_b16 v[130:131], v13 offset:2736
    s_waitcnt vmcnt(6)
    v_max_u32 v2, v147, v151
    v_mfma_f32_32x32x16_bf16 v[68:83], v[156:159], v[140:143], v[68:83]
    v_cmp_eq_u32 vcc, -1, v2
    buffer_load_dwordx4 v[112:115], v15, s[52:55], s93 offen offset:2048 sc1
    buffer_load_dwordx4 v[116:119], v15, s[52:55], s93 offen offset:2560 sc1
    v_mfma_f32_16x16x32_bf16 v[48:51], v[160:163], v[136:139], v[48:51]
    s_cbranch_vccnz oslow_44
oslow_44_r:
    v_mfma_f32_16x16x32_bf16 v[84:87], v[160:163], v[140:143], v[84:87]
    s_waitcnt lgkmcnt(4)
    v_mfma_f32_32x32x16_bf16 v[16:31], v[120:123], v[144:147], v[16:31]
    ds_read_b64_tr_b16 v[152:153], v12 offset:5184
    ds_read_b64_tr_b16 v[154:155], v12 offset:5328
    v_mfma_f32_32x32x16_bf16 v[52:67], v[120:123], v[148:151], v[52:67]
    ds_read_b64_tr_b16 v[156:157], v12 offset:5248
    ds_read_b64_tr_b16 v[158:159], v12 offset:5392
    s_waitcnt lgkmcnt(4)
    v_mfma_f32_32x32x16_bf16 v[32:47], v[124:127], v[144:147], v[32:47]
    ds_read_b64_tr_b16 v[160:161], v13 offset:5184
    ds_read_b64_tr_b16 v[162:163], v13 offset:5328
    s_waitcnt vmcnt(6)
    v_max_u32 v2, v91, v95
    v_mfma_f32_32x32x16_bf16 v[68:83], v[124:127], v[148:151], v[68:83]
    v_cmp_eq_u32 vcc, -1, v2
    s_add_u32 s8, s93, 4096
    buffer_load_dwordx4 v[4:7], v15, s[52:55], s8 offen offset:0 sc1
    buffer_load_dwordx4 v[8:11], v15, s[52:55], s8 offen offset:512 sc1
    v_mfma_f32_16x16x32_bf16 v[48:51], v[128:131], v[144:147], v[48:51]
    s_cbranch_vccnz oslow_45
oslow_45_r:
    v_mfma_f32_16x16x32_bf16 v[84:87], v[128:131], v[148:151], v[84:87]
    s_waitcnt lgkmcnt(4)
    v_mfma_f32_32x32x16_bf16 v[16:31], v[152:155], v[88:91], v[16:31]
    ds_read_b64_tr_b16 v[120:121], v12 offset:7776
    ds_read_b64_tr_b16 v[122:123], v12 offset:7920
    v_mfma_f32_32x32x16_bf16 v[52:67], v[152:155], v[92:95], v[52:67]
    ds_read_b64_tr_b16 v[124:125], v12 offset:7840
    ds_read_b64_tr_b16 v[126:127], v12 offset:7984
    s_waitcnt lgkmcnt(4)
    v_mfma_f32_32x32x16_bf16 v[32:47], v[156:159], v[88:91], v[32:47]
    ds_read_b64_tr_b16 v[128:129], v13 offset:7776
    ds_read_b64_tr_b16 v[130:131], v13 offset:7920
    s_waitcnt vmcnt(6)
    v_max_u32 v2, v99, v103
    v_mfma_f32_32x32x16_bf16 v[68:83], v[156:159], v[92:95], v[68:83]
    v_cmp_eq_u32 vcc, -1, v2
    s_add_u32 s8, s93, 4096
    buffer_load_dwordx4 v[136:139], v15, s[52:55], s8 offen offset:2048 sc1
    buffer_load_dwordx4 v[140:143], v15, s[52:55], s8 offen offset:2560 sc1
    v_mfma_f32_16x16x32_bf16 v[48:51], v[160:163], v[88:91], v[48:51]
    s_cbranch_vccnz oslow_46
oslow_46_r:
    v_mfma_f32_16x16x32_bf16 v[84:87], v[160:163], v[92:95], v[84:87]
    s_waitcnt lgkmcnt(4)
    v_mfma_f32_32x32x16_bf16 v[16:31], v[120:123], v[96:99], v[16:31]
    v_add_u32 v12, s92, v12
    ds_read_b64_tr_b16 v[152:153], v12 offset:0
    ds_read_b64_tr_b16 v[154:155], v12 offset:144
    v_mfma_f32_32x32x16_bf16 v[52:67], v[120:123], v[100:103], v[52:67]
    ds_read_b64_tr_b16 v[156:157], v12 offset:64
    ds_read_b64_tr_b16 v[158:159], v12 offset:208
    s_waitcnt lgkmcnt(4)
    v_mfma_f32_32x32x16_bf16 v[32:47], v[124:127], v[96:99], v[32:47]
    v_add_u32 v13, s92, v13
    ds_read_b64_tr_b16 v[160:161], v13 offset:0
    ds_read_b64_tr_b16 v[162:163], v13 offset:144
    s_waitcnt vmcnt(6)
    v_max_u32 v2, v107, v111
    v_mfma_f32_32x32x16_bf16 v[68:83], v[124:127], v[100:103], v[68:83]
    v_cmp_eq_u32 vcc, -1, v2
    buffer_load_dwordx4 v[144:147], v15, s[52:55], s95 offen offset:0 sc1
    buffer_load_dwordx4 v[148:151], v15, s[52:55], s95 offen offset:512 sc1
    v_lshl_add_u32 v132, v133, 4, v132
    v_mul_u32_u24 v132, 288, v132
    v_bfe_u32 v133, v0, 4, 1
    v_mfma_f32_16x16x32_bf16 v[48:51], v[128:131], v[96:99], v[48:51]
    s_cbranch_vccnz oslow_47
oslow_47_r:
    v_mfma_f32_16x16x32_bf16 v[84:87], v[128:131], v[100:103], v[84:87]
    s_waitcnt lgkmcnt(4)
    v_mfma_f32_32x32x16_bf16 v[16:31], v[152:155], v[104:107], v[16:31]
    ds_read_b64_tr_b16 v[120:121], v12 offset:2592
    ds_read_b64_tr_b16 v[122:123], v12 offset:2736
    v_mfma_f32_32x32x16_bf16 v[52:67], v[152:155], v[108:111], v[52:67]
    ds_read_b64_tr_b16 v[124:125], v12 offset:2656
    ds_read_b64_tr_b16 v[126:127], v12 offset:2800
    s_waitcnt lgkmcnt(4)
    v_mfma_f32_32x32x16_bf16 v[32:47], v[156:159], v[104:107], v[32:47]
    ds_read_b64_tr_b16 v[128:129], v13 offset:2592
    ds_read_b64_tr_b16 v[130:131], v13 offset:2736
    s_waitcnt vmcnt(6)
    v_max_u32 v2, v115, v119
    v_mfma_f32_32x32x16_bf16 v[68:83], v[156:159], v[108:111], v[68:83]
    v_cmp_eq_u32 vcc, -1, v2
    v_lshl_add_u32 v132, v133, 4, v132
    v_add_u32 v164, s85, v132
    v_mfma_f32_16x16x32_bf16 v[48:51], v[160:163], v[104:107], v[48:51]
    s_cbranch_vccnz oslow_48
oslow_48_r:
    v_mfma_f32_16x16x32_bf16 v[84:87], v[160:163], v[108:111], v[84:87]
    s_waitcnt lgkmcnt(4)
    v_mfma_f32_32x32x16_bf16 v[16:31], v[120:123], v[112:115], v[16:31]
    ds_read_b64_tr_b16 v[152:153], v12 offset:5184
    ds_read_b64_tr_b16 v[154:155], v12 offset:5328
    v_mfma_f32_32x32x16_bf16 v[52:67], v[120:123], v[116:119], v[52:67]
    ds_read_b64_tr_b16 v[156:157], v12 offset:7776
    ds_read_b64_tr_b16 v[158:159], v12 offset:7920
    s_waitcnt lgkmcnt(4)
    v_mfma_f32_32x32x16_bf16 v[32:47], v[124:127], v[112:115], v[32:47]
    ds_read_b64_tr_b16 v[160:161], v165 offset:0
    ds_read_b64_tr_b16 v[162:163], v165 offset:5184
    s_waitcnt vmcnt(4)
    v_max_u32 v2, v7, v11
    v_mfma_f32_32x32x16_bf16 v[68:83], v[124:127], v[116:119], v[68:83]
    v_cmp_eq_u32 vcc, -1, v2
    v_mfma_f32_16x16x32_bf16 v[48:51], v[128:131], v[112:115], v[48:51]
    s_cbranch_vccnz oslow_49
oslow_49_r:
    v_mfma_f32_16x16x32_bf16 v[84:87], v[128:131], v[116:119], v[84:87]
    s_waitcnt lgkmcnt(4)
    v_mfma_f32_32x32x16_bf16 v[16:31], v[152:155], v[4:7], v[16:31]
    ds_read_b64_tr_b16 v[120:121], v12 offset:5248
    ds_read_b64_tr_b16 v[122:123], v12 offset:5392
    s_waitcnt vmcnt(2)
    v_max_u32 v2, v139, v143
    v_cmp_eq_u32 vcc, -1, v2
    v_mfma_f32_32x32x16_bf16 v[52:67], v[152:155], v[8:11], v[52:67]
    s_cbranch_vccnz oslow_50
oslow_50_r:
    ds_read_b64_tr_b16 v[152:153], v13 offset:5184
    ds_read_b64_tr_b16 v[154:155], v13 offset:5328
    s_waitcnt lgkmcnt(6)
    v_mfma_f32_32x32x16_bf16 v[16:31], v[156:159], v[136:139], v[16:31]
    ds_read_b64_tr_b16 v[124:125], v12 offset:7840
    ds_read_b64_tr_b16 v[126:127], v12 offset:7984
    s_waitcnt vmcnt(0)
    v_max3_u32 v2, v144, v145, v146
    v_max3_u32 v2, v2, v147, v148
    v_max3_u32 v2, v2, v149, v150
    v_max_u32 v2, v2, v151
    v_cmp_eq_u32 vcc, -1, v2
    v_mfma_f32_32x32x16_bf16 v[52:67], v[156:159], v[140:143], v[52:67]
    s_cbranch_vccnz oslow_51
oslow_51_r:
    ds_read_b64_tr_b16 v[156:157], v13 offset:7776
    ds_read_b64_tr_b16 v[158:159], v13 offset:7920
    s_waitcnt lgkmcnt(8)
    v_mfma_f32_32x32x16_bf16 v[16:31], v[160:163], v[144:147], v[16:31]
    ds_read_b64_tr_b16 v[128:129], v165 offset:64
    ds_read_b64_tr_b16 v[130:131], v165 offset:5248
    v_mfma_f32_32x32x16_bf16 v[52:67], v[160:163], v[148:151], v[52:67]
    ds_read_b64_tr_b16 v[160:161], v166 offset:0
    ds_read_b64_tr_b16 v[162:163], v166 offset:5184
    s_waitcnt lgkmcnt(10)
    v_mfma_f32_32x32x16_bf16 v[32:47], v[120:123], v[4:7], v[32:47]
    s_waitcnt lgkmcnt(6)
    v_mfma_f32_32x32x16_bf16 v[32:47], v[124:127], v[136:139], v[32:47]
    s_waitcnt lgkmcnt(0)
    v_mfma_f32_32x32x16_bf16 v[32:47], v[128:131], v[144:147], v[32:47]
    s_nop 0
    ds_write_b128 v14, v[16:19] offset:0
    v_mfma_f32_32x32x16_bf16 v[68:83], v[120:123], v[8:11], v[68:83]
    ds_write_b128 v14, v[20:23] offset:32
    v_mfma_f32_32x32x16_bf16 v[68:83], v[124:127], v[140:143], v[68:83]
    ds_write_b128 v14, v[24:27] offset:64
    v_mfma_f32_32x32x16_bf16 v[68:83], v[128:131], v[148:151], v[68:83]
    ds_write_b128 v14, v[28:31] offset:96
    v_mfma_f32_16x16x32_bf16 v[48:51], v[152:155], v[4:7], v[48:51]
    v_mfma_f32_16x16x32_bf16 v[48:51], v[156:159], v[136:139], v[48:51]
    v_mfma_f32_16x16x32_bf16 v[48:51], v[160:163], v[144:147], v[48:51]
    ds_write_b128 v14, v[52:55] offset:9216
    v_mfma_f32_16x16x32_bf16 v[84:87], v[152:155], v[8:11], v[84:87]
    v_mfma_f32_16x16x32_bf16 v[84:87], v[156:159], v[140:143], v[84:87]
    v_mfma_f32_16x16x32_bf16 v[84:87], v[160:163], v[148:151], v[84:87]
    ds_write_b128 v14, v[56:59] offset:9248
    ds_write_b128 v14, v[60:63] offset:9280
    ds_write_b128 v14, v[64:67] offset:9312
    ds_write_b128 v14, v[32:35] offset:128
    ds_write_b128 v14, v[36:39] offset:160
    ds_write_b128 v14, v[40:43] offset:192
    ds_write_b128 v14, v[44:47] offset:224
    ds_write_b128 v14, v[68:71] offset:9344
    ds_write_b128 v14, v[72:75] offset:9376
    ds_write_b128 v14, v[76:79] offset:9408
    ds_write_b128 v14, v[80:83] offset:9440
    ds_write_b128 v164, v[48:51] offset:256
    ds_write_b128 v164, v[84:87] offset:9472
    s_waitcnt lgkmcnt(0)
    s_barrier
    s_endpgm
wosync_42:
    s_mov_b32 s15, 0
lw_53:
    ds_read_b32 v1, v164 offset:64
    s_waitcnt lgkmcnt(0)
    v_cmp_gt_u32 vcc, 4, v1
    s_nop 0
    s_cbranch_vccz lwd_54
    s_sleep 0
    s_add_u32 s15, s15, 1
    s_cmp_lt_u32 s15, 0x100000
    s_cbranch_scc1 lw_53
lwd_54:
    s_branch wosync_42_r
oslow_43:
    s_sleep 1
    buffer_load_dwordx4 v[136:139], v15, s[52:55], s13 offen offset:0 sc1
    buffer_load_dwordx4 v[140:143], v15, s[52:55], s13 offen offset:512 sc1
    buffer_load_dwordx4 v[144:147], v15, s[52:55], s13 offen offset:2048 sc1
    buffer_load_dwordx4 v[148:151], v15, s[52:55], s13 offen offset:2560 sc1
    s_add_u32 s8, s13, 4096
    buffer_load_dwordx4 v[88:91], v15, s[52:55], s8 offen offset:0 sc1
    buffer_load_dwordx4 v[92:95], v15, s[52:55], s8 offen offset:512 sc1
    s_add_u32 s8, s13, 4096
    buffer_load_dwordx4 v[96:99], v15, s[52:55], s8 offen offset:2048 sc1
    buffer_load_dwordx4 v[100:103], v15, s[52:55], s8 offen offset:2560 sc1
    s_waitcnt vmcnt(0)
    v_max_u32 v2, v139, v143
    v_cmp_eq_u32 vcc, -1, v2
    s_add_u32 s94, s94, 1
    s_cmp_ge_u32 s94, 0x4000
    s_cbranch_scc1 oslow_43_r
    s_cbranch_vccnz oslow_43
    s_branch oslow_43_r
oslow_44:
    s_sleep 1
    buffer_load_dwordx4 v[144:147], v15, s[52:55], s13 offen offset:2048 sc1
    buffer_load_dwordx4 v[148:151], v15, s[52:55], s13 offen offset:2560 sc1
    s_add_u32 s8, s13, 4096
    buffer_load_dwordx4 v[88:91], v15, s[52:55], s8 offen offset:0 sc1
    buffer_load_dwordx4 v[92:95], v15, s[52:55], s8 offen offset:512 sc1
    s_add_u32 s8, s13, 4096
    buffer_load_dwordx4 v[96:99], v15, s[52:55], s8 offen offset:2048 sc1
    buffer_load_dwordx4 v[100:103], v15, s[52:55], s8 offen offset:2560 sc1
    s_waitcnt vmcnt(0)
    v_max_u32 v2, v147, v151
    v_cmp_eq_u32 vcc, -1, v2
    s_add_u32 s94, s94, 1
    s_cmp_ge_u32 s94, 0x4000
    s_cbranch_scc1 oslow_44_r
    s_cbranch_vccnz oslow_44
    s_branch oslow_44_r
oslow_45:
    s_sleep 1
    s_add_u32 s8, s13, 4096
    buffer_load_dwordx4 v[88:91], v15, s[52:55], s8 offen offset:0 sc1
    buffer_load_dwordx4 v[92:95], v15, s[52:55], s8 offen offset:512 sc1
    s_add_u32 s8, s13, 4096
    buffer_load_dwordx4 v[96:99], v15, s[52:55], s8 offen offset:2048 sc1
    buffer_load_dwordx4 v[100:103], v15, s[52:55], s8 offen offset:2560 sc1
    s_waitcnt vmcnt(0)
    v_max_u32 v2, v91, v95
    v_cmp_eq_u32 vcc, -1, v2
    s_add_u32 s94, s94, 1
    s_cmp_ge_u32 s94, 0x4000
    s_cbranch_scc1 oslow_45_r
    s_cbranch_vccnz oslow_45
    s_branch oslow_45_r
oslow_46:
    s_sleep 1
    s_add_u32 s8, s13, 4096
    buffer_load_dwordx4 v[96:99], v15, s[52:55], s8 offen offset:2048 sc1
    buffer_load_dwordx4 v[100:103], v15, s[52:55], s8 offen offset:2560 sc1
    s_waitcnt vmcnt(0)
    v_max_u32 v2, v99, v103
    v_cmp_eq_u32 vcc, -1, v2
    s_add_u32 s94, s94, 1
    s_cmp_ge_u32 s94, 0x4000
    s_cbranch_scc1 oslow_46_r
    s_cbranch_vccnz oslow_46
    s_branch oslow_46_r
oslow_47:
    s_sleep 1
    buffer_load_dwordx4 v[104:107], v15, s[52:55], s93 offen offset:0 sc1
    buffer_load_dwordx4 v[108:111], v15, s[52:55], s93 offen offset:512 sc1
    buffer_load_dwordx4 v[112:115], v15, s[52:55], s93 offen offset:2048 sc1
    buffer_load_dwordx4 v[116:119], v15, s[52:55], s93 offen offset:2560 sc1
    s_add_u32 s8, s93, 4096
    buffer_load_dwordx4 v[4:7], v15, s[52:55], s8 offen offset:0 sc1
    buffer_load_dwordx4 v[8:11], v15, s[52:55], s8 offen offset:512 sc1
    s_add_u32 s8, s93, 4096
    buffer_load_dwordx4 v[136:139], v15, s[52:55], s8 offen offset:2048 sc1
    buffer_load_dwordx4 v[140:143], v15, s[52:55], s8 offen offset:2560 sc1
    buffer_load_dwordx4 v[144:147], v15, s[52:55], s95 offen offset:0 sc1
    buffer_load_dwordx4 v[148:151], v15, s[52:55], s95 offen offset:512 sc1
    s_waitcnt vmcnt(0)
    v_max_u32 v2, v107, v111
    v_cmp_eq_u32 vcc, -1, v2
    s_add_u32 s94, s94, 1
    s_cmp_ge_u32 s94, 0x4000
    s_cbranch_scc1 oslow_47_r
    s_cbranch_vccnz oslow_47
    s_branch oslow_47_r
oslow_48:
    s_sleep 1
    buffer_load_dwordx4 v[112:115], v15, s[52:55], s93 offen offset:2048 sc1
    buffer_load_dwordx4 v[116:119], v15, s[52:55], s93 offen offset:2560 sc1
    s_add_u32 s8, s93, 4096
    buffer_load_dwordx4 v[4:7], v15, s[52:55], s8 offen offset:0 sc1
    buffer_load_dwordx4 v[8:11], v15, s[52:55], s8 offen offset:512 sc1
    s_add_u32 s8, s93, 4096
    buffer_load_dwordx4 v[136:139], v15, s[52:55], s8 offen offset:2048 sc1
    buffer_load_dwordx4 v[140:143], v15, s[52:55], s8 offen offset:2560 sc1
    buffer_load_dwordx4 v[144:147], v15, s[52:55], s95 offen offset:0 sc1
    buffer_load_dwordx4 v[148:151], v15, s[52:55], s95 offen offset:512 sc1
    s_waitcnt vmcnt(0)
    v_max_u32 v2, v115, v119
    v_cmp_eq_u32 vcc, -1, v2
    s_add_u32 s94, s94, 1
    s_cmp_ge_u32 s94, 0x4000
    s_cbranch_scc1 oslow_48_r
    s_cbranch_vccnz oslow_48
    s_branch oslow_48_r
oslow_49:
    s_sleep 1
    s_add_u32 s8, s93, 4096
    buffer_load_dwordx4 v[4:7], v15, s[52:55], s8 offen offset:0 sc1
    buffer_load_dwordx4 v[8:11], v15, s[52:55], s8 offen offset:512 sc1
    s_add_u32 s8, s93, 4096
    buffer_load_dwordx4 v[136:139], v15, s[52:55], s8 offen offset:2048 sc1
    buffer_load_dwordx4 v[140:143], v15, s[52:55], s8 offen offset:2560 sc1
    buffer_load_dwordx4 v[144:147], v15, s[52:55], s95 offen offset:0 sc1
    buffer_load_dwordx4 v[148:151], v15, s[52:55], s95 offen offset:512 sc1
    s_waitcnt vmcnt(0)
    v_max_u32 v2, v7, v11
    v_cmp_eq_u32 vcc, -1, v2
    s_add_u32 s94, s94, 1
    s_cmp_ge_u32 s94, 0x4000
    s_cbranch_scc1 oslow_49_r
    s_cbranch_vccnz oslow_49
    s_branch oslow_49_r
oslow_50:
    s_sleep 1
    s_add_u32 s8, s93, 4096
    buffer_load_dwordx4 v[136:139], v15, s[52:55], s8 offen offset:2048 sc1
    buffer_load_dwordx4 v[140:143], v15, s[52:55], s8 offen offset:2560 sc1
    buffer_load_dwordx4 v[144:147], v15, s[52:55], s95 offen offset:0 sc1
    buffer_load_dwordx4 v[148:151], v15, s[52:55], s95 offen offset:512 sc1
    s_waitcnt vmcnt(0)
    v_max_u32 v2, v139, v143
    v_cmp_eq_u32 vcc, -1, v2
    s_add_u32 s94, s94, 1
    s_cmp_ge_u32 s94, 0x4000
    s_cbranch_scc1 oslow_50_r
    s_cbranch_vccnz oslow_50
    s_branch oslow_50_r
oslow_51:
    s_sleep 1
    buffer_load_dwordx4 v[144:147], v15, s[52:55], s95 offen offset:0 sc1
    buffer_load_dwordx4 v[148:151], v15, s[52:55], s95 offen offset:512 sc1
    s_waitcnt vmcnt(0)
    v_max3_u32 v2, v144, v145, v146
    v_max3_u32 v2, v2, v147, v148
    v_max3_u32 v2, v2, v149, v150
    v_max_u32 v2, v2, v151
    v_cmp_eq_u32 vcc, -1, v2
    s_add_u32 s94, s94, 1
    s_cmp_ge_u32 s94, 0x4000
    s_cbranch_scc1 oslow_51_r
    s_cbranch_vccnz oslow_51
    s_branch oslow_51_r
.p2align 6
L_att:
    s_add_u32 s80, s3, s4
    s_mul_i32 s8, s80, 43
    s_lshr_b32 s8, s8, 7
    s_mul_i32 s8, s8, 3
    s_sub_u32 s80, s80, s8
    s_and_b32 s82, s5, 1
    s_lshr_b32 s83, s5, 1
    v_lshlrev_b32 v10, 4, v0
    v_lshrrev_b32 v116, 5, v0
    v_mov_b32 v6, 1
    v_mov_b32 v135, 162720
    s_cmp_ge_u32 s5, 5
    s_cbranch_scc1 L_stream
    s_sub_u32 s11, s5, 2
    s_and_b32 s8, s4, 3
    s_lshl_b32 s9, s8, 11
    s_mul_i32 s10, s11, 24576
    s_add_u32 s9, s9, s10
    v_and_b32 v1, 15, v0
    v_lshrrev_b32 v13, 4, v0
    v_lshrrev_b32 v14, 1, v1
    v_xor_b32 v14, v14, v13
    v_lshlrev_b32 v14, 4, v14
    v_lshl_add_u32 v14, v1, 7, v14
    v_add_u32 v145, s9, v14
    v_xor_b32 v146, 64, v145
    v_bfe_u32 v1, v0, 2, 2
    v_lshl_add_u32 v1, v13, 3, v1
    v_mul_u32_u24 v1, 48, v1
    v_and_b32 v14, 3, v0
    s_add_u32 s9, s11, s80
    s_sub_u32 s10, s9, 3
    s_cmp_ge_u32 s9, 3
    s_cselect_b32 s9, s10, s9
    s_mul_i32 s9, s9, 9216
    s_add_u32 s9, s9, 73728
    v_add_u32 v1, s9, v1
    v_lshl_add_u32 v147, v14, 3, v1
    v_lshl_add_u32 v133, v14, 18, v1
    s_lshl_b32 s9, s11, 11
    s_add_u32 s9, s9, 151168
    v_add_u32 v12, s9, v10
    v_mov_b32 v1, 162560
    v_lshl_add_u32 v1, v0, 2, v1
    s_mov_b32 vcc_lo, 0xe01f00
    s_mov_b32 vcc_hi, 0x40000
    v_cndmask_b32 v13, 0, 12, vcc
    ds_write_b32 v1, v13
    s_mov_b64 exec, -1
    v_mov_b32 v132, 162640
    v_lshl_add_u32 v136, v0, 18, v132
    v_mov_b32 v137, 2146435072
    v_mov_b32 v134, 2146435072
    s_waitcnt lgkmcnt(0)
    s_load_dword s6, s[50:51], 0
    s_mov_b32 s52, s50
    s_mov_b32 s53, s51
    s_mov_b32 s54, 8388608
    s_mov_b32 s55, 0x20000
    s_barrier
    s_cmp_lg_u32 s5, 4
    s_cbranch_scc1 su_d_55
    s_setprio 3
    s_lshr_b32 s11, s3, 1
    s_mul_i32 s11, s11, 10240
    s_add_u32 s11, s11, 75776
    s_and_b32 s9, s3, 1
    s_lshl_b32 s9, s9, 1
    s_bfe_u32 s8, s4, 0x10001
    s_add_u32 s9, s9, s8
    s_mul_i32 s12, s9, 2304
    s_add_u32 s12, s12, s11
    s_lshl_b32 s9, s9, 2
    s_add_u32 s11, s11, s9
    s_sub_u32 s11, s11, 1024
    s_and_b32 s8, s4, 1
    s_lshl_b32 s13, s3, 3
    s_add_u32 s13, s13, s4
    s_lshl_b32 s13, s13, 3
    s_add_u32 s13, s13, 4096
    v_and_b32 v1, 15, v0
    v_bfe_u32 v13, v0, 4, 1
    v_mov_b32 v15, 2146435072
    v_add_u32 v144, 151168, v10
    s_cmp_ge_u32 s4, 4
    s_cbranch_scc1 ksv_56
    s_bitcmp1_b32 s3, 0
    s_mov_b32 s9, 5632
    s_cselect_b32 s9, 4608, s9
    s_sub_u32 s12, s12, s9
    s_lshl_b32 s8, s8, 4
    v_add_u32 v1, s8, v1
    v_lshlrev_b32 v14, 9, v116
    v_lshl_add_u32 v14, v1, 4, v14
    v_lshl_add_u32 v137, v13, 3, v14
    v_lshlrev_b32 v1, 4, v1
    s_mov_b64 vcc, 0xffff
    v_cndmask_b32 v134, v15, v1, vcc
    buffer_load_dword v160, v137, s[52:55], s12 offen sc1
    buffer_load_dword v160, v134, s[52:55], s11 offen sc1
    s_branch ksj_57
ksv_56:
    s_mul_i32 s8, s8, 640
    s_add_u32 s12, s12, s8
    v_mul_u32_u24 v139, 304, v116
    v_lshl_add_u32 v139, v13, 3, v139
    v_lshrrev_b32 v14, 2, v1
    v_and_b32 v13, 2, v1
    v_lshl_add_u32 v14, v13, 1, v14
    v_and_b32 v13, 1, v1
    v_lshl_add_u32 v14, v13, 3, v14
    v_lshl_add_u32 v137, v14, 4, v139
    v_lshl_add_u32 v13, v1, 4, v139
    v_cmp_gt_u32 vcc, 3, v1
    s_nop 1
    v_cndmask_b32 v134, v15, v13, vcc
    buffer_load_dword v160, v137, s[52:55], s12 offen offset:1024 sc1
    buffer_load_dword v160, v134, s[52:55], s12 offen offset:1280 sc1
ksj_57:
    v_mov_b32 v148, -1
    v_mov_b32 v149, -1
    v_mov_b32 v150, -1
    v_mov_b32 v151, -1
    s_sub_u32 s8, 31, s3
    s_mul_i32 s8, s8, 5120
    s_mul_i32 s9, s4, 640
    s_add_u32 s8, s8, s9
    s_add_u32 s8, s8, 262144
    s_mov_b32 exec_hi, 0xff
    buffer_store_dwordx4 v[148:151], v10, s[52:55], s8 offen sc1
    s_mov_b32 exec_hi, -1
    v_mov_b32 v161, 0
    buffer_load_dword v160, v161, s[52:55], s13 offen sc1
    s_waitcnt lgkmcnt(0)
    s_mul_i32 s6, s6, 0x9E3779B1
    s_add_u32 s6, s6, 0x7F4A7C15
su_d_55:
    v_and_b32 v1, 31, v0
    v_lshrrev_b32 v13, 5, v0
    v_bfe_u32 v14, v0, 1, 3
    v_xor_b32 v13, v13, v14
    v_lshlrev_b32 v13, 4, v13
    v_lshl_add_u32 v128, v1, 7, v13
    v_xor_b32 v129, 32, v128
    v_xor_b32 v130, 64, v128
    v_xor_b32 v131, 96, v128
    v_add_u32 v2, 73728, v10
    v_and_b32 v117, 31, v0
    v_add_u32 v1, 82944, v10
    v_mov_b32 v13, 75040
    v_cmp_gt_u32 vcc, 32, v0
    s_nop 1
    v_cndmask_b32 v3, v13, v1, vcc
    v_mad_u32_u24 v1, v116, 19, v117
    v_lshlrev_b32 v1, 4, v1
    v_add_u32 v1, 74752, v1
    v_mov_b32 v118, 262144
    v_cmp_gt_u32 vcc, 19, v117
    s_nop 1
    v_cndmask_b32 v4, v118, v1, vcc
    v_mov_b32 v5, 0xdddddddd
    s_lshl_b32 s8, s5, 2
    s_add_u32 s8, s8, 162560
    v_mov_b32 v1, s8
    v_cmp_eq_u32 vcc, 0, v0
    s_nop 1
    v_cndmask_b32 v7, v118, v1, vcc
    v_and_b32 v1, 15, v0
    v_min_u32 v1, 12, v1
    v_lshlrev_b32 v1, 2, v1
    v_add_u32 v8, 162560, v1
    v_lshlrev_b32 v11, 2, v0
    v_and_b32 v9, 12, v11
    v_add_u32 v9, 162688, v9
    s_lshl_b32 s8, s82, 5
    v_add_u32 v119, s8, v117
    v_mul_u32_u24 v120, 148, v119
    s_mul_i32 s8, s83, 36
    s_add_u32 s8, s8, 148224
    v_add_u32 v120, s8, v120
    v_lshl_add_u32 v121, v116, 18, v120
    v_lshl_add_u32 v120, v116, 4, v120
    v_mov_b32 v122, 162656
    v_add_u32 v72, 139776, v10
    v_add_u32 v1, 2048, v72
    v_cmp_gt_u32 vcc, 32, v0
    s_nop 1
    v_cndmask_b32 v73, v3, v1, vcc
    s_mov_b32 s56, s52
    s_mov_b32 s57, s53
    s_mov_b32 s58, s54
    s_mov_b32 s59, 0x20000
    s_mul_i32 s8, s5, 1280
    s_add_u32 s86, s8, 73728
    s_add_u32 s87, s8, 86016
    s_mov_b32 s84, 0
    v_lshlrev_b32 v141, 4, v119
    v_lshl_add_u32 v140, v116, 10, v141
    v_lshl_add_u32 v141, v116, 30, v141
    v_lshlrev_b32 v119, 3, v119
    v_add_u32 v119, 163072, v119
    s_mul_i32 s8, s3, 73728
    s_add_u32 s8, s8, 5242880
    s_lshl_b32 s10, s4, 2
    s_add_u32 s10, s10, s83
    s_lshl_b32 s9, s10, 11
    s_add_u32 s88, s9, s8
    s_lshl_b32 s14, s4, 10
    s_add_u32 s8, s8, s14
    s_lshl_b32 s14, s83, 2
    s_add_u32 s8, s8, s14
    s_add_u32 s89, s8, 65536
    v_mov_b32 v80, 0
    v_mov_b32 v81, 0
    v_mov_b32 v82, 0
    v_mov_b32 v83, 0
    v_mov_b32 v84, 0
    v_mov_b32 v85, 0
    v_mov_b32 v86, 0
    v_mov_b32 v87, 0
    v_mov_b32 v88, 0
    v_mov_b32 v89, 0
    v_mov_b32 v90, 0
    v_mov_b32 v91, 0
    v_mov_b32 v92, 0
    v_mov_b32 v93, 0
    v_mov_b32 v94, 0
    v_mov_b32 v95, 0
    s_cmp_lt_u32 s5, 2
    s_cbranch_scc1 L_gen
    s_mov_b32 s15, 0
lw_58:
    ds_read_b32 v1, v135 offset:0
    s_waitcnt lgkmcnt(0)
    v_cmp_gt_u32 vcc, 4, v1
    s_nop 0
    s_cbranch_vccz lwd_59
    s_sleep 0
    s_add_u32 s15, s15, 1
    s_cmp_lt_u32 s15, 0x100000
    s_cbranch_scc1 lw_58
lwd_59:
    ds_read_b128 v[16:19], v145 offset:0
    ds_read_b64_tr_b16 v[20:21], v147 offset:0
    ds_read_b64_tr_b16 v[22:23], v147 offset:192
    ds_read_b64_tr_b16 v[24:25], v133 offset:32
    ds_read_b64_tr_b16 v[26:27], v133 offset:224
    ds_read_b128 v[28:31], v146 offset:0
    ds_read_b64_tr_b16 v[32:33], v147 offset:1536
    ds_read_b64_tr_b16 v[34:35], v147 offset:1728
    ds_read_b64_tr_b16 v[36:37], v133 offset:1568
    ds_read_b64_tr_b16 v[38:39], v133 offset:1760
    ds_read_b128 v[40:43], v145 offset:8192
    ds_read_b64_tr_b16 v[44:45], v147 offset:3072
    ds_read_b64_tr_b16 v[46:47], v147 offset:3264
    ds_read_b64_tr_b16 v[48:49], v133 offset:3104
    ds_read_b64_tr_b16 v[50:51], v133 offset:3296
    ds_read_b128 v[52:55], v146 offset:8192
    ds_read_b64_tr_b16 v[56:57], v147 offset:4608
    ds_read_b64_tr_b16 v[58:59], v147 offset:4800
    ds_read_b64_tr_b16 v[60:61], v133 offset:4640
    ds_read_b64_tr_b16 v[62:63], v133 offset:4832
    ds_read_b128 v[148:151], v145 offset:16384
    ds_read_b64_tr_b16 v[152:153], v147 offset:6144
    ds_read_b64_tr_b16 v[154:155], v147 offset:6336
    ds_read_b64_tr_b16 v[156:157], v133 offset:6176
    ds_read_b64_tr_b16 v[158:159], v133 offset:6368
    ds_read_b128 v[96:99], v146 offset:16384
    ds_read_b64_tr_b16 v[100:101], v147 offset:7680
    ds_read_b64_tr_b16 v[102:103], v147 offset:7872
    ds_read_b64_tr_b16 v[104:105], v133 offset:7712
    ds_read_b64_tr_b16 v[106:107], v133 offset:7904
    s_cmp_ge_u32 s4, 4
    s_cbranch_scc1 kvv_60
    s_waitcnt lgkmcnt(15)
    v_mfma_f32_16x16x32_bf16 v[64:67], v[20:23], v[16:19], 0
    v_mfma_f32_16x16x32_bf16 v[68:71], v[24:27], v[16:19], 0
    v_mfma_f32_16x16x32_bf16 v[64:67], v[32:35], v[28:31], v[64:67]
    v_mfma_f32_16x16x32_bf16 v[68:71], v[36:39], v[28:31], v[68:71]
    s_waitcnt lgkmcnt(15)
    v_mfma_f32_16x16x32_bf16 v[64:67], v[44:47], v[40:43], v[64:67]
    v_mfma_f32_16x16x32_bf16 v[68:71], v[48:51], v[40:43], v[68:71]
    s_waitcnt lgkmcnt(10)
    v_mfma_f32_16x16x32_bf16 v[64:67], v[56:59], v[52:55], v[64:67]
    v_mfma_f32_16x16x32_bf16 v[68:71], v[60:63], v[52:55], v[68:71]
    s_waitcnt lgkmcnt(5)
    v_mfma_f32_16x16x32_bf16 v[64:67], v[152:155], v[148:151], v[64:67]
    v_mfma_f32_16x16x32_bf16 v[68:71], v[156:159], v[148:151], v[68:71]
    s_waitcnt lgkmcnt(0)
    v_mfma_f32_16x16x32_bf16 v[64:67], v[100:103], v[96:99], v[64:67]
    v_mfma_f32_16x16x32_bf16 v[68:71], v[104:107], v[96:99], v[68:71]
    s_branch kvj_61
kvv_60:
    s_waitcnt lgkmcnt(15)
    v_mfma_f32_16x16x32_bf16 v[64:67], v[16:19], v[20:23], 0
    v_mfma_f32_16x16x32_bf16 v[68:71], v[16:19], v[24:27], 0
    v_mfma_f32_16x16x32_bf16 v[64:67], v[28:31], v[32:35], v[64:67]
    v_mfma_f32_16x16x32_bf16 v[68:71], v[28:31], v[36:39], v[68:71]
    s_waitcnt lgkmcnt(15)
    v_mfma_f32_16x16x32_bf16 v[64:67], v[40:43], v[44:47], v[64:67]
    v_mfma_f32_16x16x32_bf16 v[68:71], v[40:43], v[48:51], v[68:71]
    s_waitcnt lgkmcnt(10)
    v_mfma_f32_16x16x32_bf16 v[64:67], v[52:55], v[56:59], v[64:67]
    v_mfma_f32_16x16x32_bf16 v[68:71], v[52:55], v[60:63], v[68:71]
    s_waitcnt lgkmcnt(5)
    v_mfma_f32_16x16x32_bf16 v[64:67], v[148:151], v[152:155], v[64:67]
    v_mfma_f32_16x16x32_bf16 v[68:71], v[148:151], v[156:159], v[68:71]
    s_waitcnt lgkmcnt(0)
    v_mfma_f32_16x16x32_bf16 v[64:67], v[96:99], v[100:103], v[64:67]
    v_mfma_f32_16x16x32_bf16 v[68:71], v[96:99], v[104:107], v[68:71]
kvj_61:
    s_cmp_eq_u32 s5, 4
    s_cbranch_scc1 L_kv_pub
    s_nop 5
    ds_write_b128 v12, v[64:67]
    ds_write_b128 v12, v[68:71] offset:1024
    ds_add_u32 v136, v6
    s_branch L_gen
L_kv_pub:
    s_mov_b32 s15, 0
lw_62:
    ds_read_b32 v1, v132 offset:0
    s_waitcnt lgkmcnt(0)
    v_cmp_gt_u32 vcc, 2, v1
    s_nop 0
    s_cbranch_vccz lwd_63
    s_sleep 0
    s_add_u32 s15, s15, 1
    s_cmp_lt_u32 s15, 0x100000
    s_cbranch_scc1 lw_62
lwd_63:
    ds_read_b128 v[24:27], v144 offset:0
    ds_read_b128 v[28:31], v144 offset:1024
    ds_read_b128 v[32:35], v144 offset:2048
    ds_read_b128 v[36:39], v144 offset:3072
    v_mov_b32 v42, s6
    v_mov_b32 v43, 0
    v_mov_b32 v1, 0
    s_waitcnt lgkmcnt(2)
    v_add_f32 v16, v64, v24
    v_add_f32 v17, v65, v25
    v_add_f32 v18, v66, v26
    v_add_f32 v19, v67, v27
    v_add_f32 v20, v68, v28
    v_add_f32 v21, v69, v29
    v_add_f32 v22, v70, v30
    v_add_f32 v23, v71, v31
    s_waitcnt lgkmcnt(0)
    ds_add_u32 v136, v6
    v_add_f32 v16, v16, v32
    v_add_f32 v17, v17, v33
    v_add_f32 v18, v18, v34
    v_add_f32 v19, v19, v35
    v_add_f32 v20, v20, v36
    v_add_f32 v21, v21, v37
    v_add_f32 v22, v22, v38
    v_add_f32 v23, v23, v39
    s_cmp_ge_u32 s4, 4
    s_cbranch_scc1 kvv_64
    v_mul_f32 v16, 1051597459, v16
    v_mul_f32 v17, 1051597459, v17
    v_mul_f32 v18, 1051597459, v18
    v_mul_f32 v19, 1051597459, v19
    v_mul_f32 v20, 1051597459, v20
    v_mul_f32 v21, 1051597459, v21
    v_cvt_pk_bf16_f32 v24, v16, v17
    v_cvt_pk_bf16_f32 v25, v18, v19
    v_cvt_pk_bf16_f32 v26, v20, v21
    buffer_store_dwordx2 v[24:25], v137, s[52:55], s12 offen sc1
    buffer_store_dword v26, v134, s[52:55], s11 offen sc1
    s_mov_b64 vcc, 0xffff
    v_cndmask_b32 v26, 0, v26, vcc
    v_dot2c_f32_bf16 v43, v24, v24
    v_dot2c_f32_bf16 v43, v25, v25
    v_dot2c_f32_bf16 v43, v26, v26
    s_nop 2
    v_mov_b32 v30, v43
    s_nop 1
    v_permlane16_swap_b32 v30, v43
    v_add_f32 v43, v30, v43
    v_mov_b32 v30, v43
    s_nop 1
    v_permlane32_swap_b32 v30, v43
    v_add_f32 v43, v30, v43
    s_nop 1
    v_max_f32_dpp v43, v43, v43 row_ror:8 row_mask:0xf bank_mask:0xf
    s_nop 1
    v_max_f32_dpp v43, v43, v43 row_ror:4 row_mask:0xf bank_mask:0xf
    s_nop 1
    v_max_f32_dpp v43, v43, v43 row_ror:2 row_mask:0xf bank_mask:0xf
    s_nop 1
    v_max_f32_dpp v43, v43, v43 row_ror:1 row_mask:0xf bank_mask:0xf
    s_branch kvj_65
kvv_64:
    v_cvt_pk_bf16_f32 v24, v16, v17
    v_cvt_pk_bf16_f32 v25, v18, v19
    v_cvt_pk_bf16_f32 v26, v20, v21
    v_cvt_pk_bf16_f32 v27, v22, v23
    buffer_store_dwordx2 v[24:25], v137, s[52:55], s12 offen offset:1024 sc1
    v_mov_b32 v29, 0x3f803f80
    s_mov_b32 vcc_lo, 0x00040004
    s_mov_b32 vcc_hi, 0x00040004
    v_cndmask_b32 v26, v26, v29, vcc
    v_cndmask_b32 v27, v27, v29, vcc
    buffer_store_dwordx2 v[26:27], v134, s[52:55], s12 offen offset:1280 sc1
kvj_65:
    s_waitcnt vmcnt(0)
    s_mov_b64 exec, 1
    buffer_store_dwordx2 v[42:43], v1, s[52:55], s13 offen sc1
    s_mov_b64 exec, -1
L_gen:
    s_mov_b32 s64, s46
    s_mov_b32 s65, s47
    s_mov_b32 s66, 4718592
    s_mov_b32 s67, 0x20000
    s_mov_b32 s68, s32
    s_mov_b32 s69, s33
    s_mov_b32 s70, 1152
    s_mov_b32 s71, 0x20000
    s_lshl_b32 s8, s3, 3
    s_add_u32 s8, s8, s5
    s_mul_i32 s8, s8, 18432
    s_mul_i32 s9, s4, 288
    s_add_u32 s90, s8, s9
    s_mul_i32 s10, s4, 18
    s_mul_i32 s11, s80, 48
    s_sub_u32 s10, s10, s11
    s_add_u32 s10, s10, 144
    s_and_b32 s11, s5, 3
    s_lshl_b32 s11, s11, 11
    s_lshr_b32 s12, s5, 2
    s_lshl_b32 s12, s12, 2
    v_add_u32 v1, 0, v0
    v_mul_u32_u24 v13, 57, v1
    v_lshrrev_b32 v13, 10, v13
    v_mul_u32_u24 v14, 126, v13
    v_add_u32 v14, v14, v1
    v_lshlrev_b32 v164, 4, v14
    v_mul_u32_u24 v14, 18, v13
    v_sub_u32 v1, v1, v14
    v_lshlrev_b32 v146, 3, v1
    v_add_u32 v1, s10, v1
    v_subrev_u32 v14, 144, v1
    v_min_u32 v1, v1, v14
    v_and_b32 v14, 3, v13
    v_add_u32 v14, s12, v14
    v_and_b32 v13, 4, v13
    v_lshrrev_b32 v15, 1, v14
    v_add_u32 v15, v15, v13
    v_lshlrev_b32 v15, 1, v15
    v_xor_b32 v15, v15, v1
    v_and_b32 v15, 15, v15
    v_lshlrev_b32 v15, 3, v15
    v_lshl_add_u32 v15, v14, 7, v15
    v_lshl_add_u32 v15, v13, 8, v15
    v_lshrrev_b32 v1, 4, v1
    v_lshl_add_u32 v15, v1, 13, v15
    v_add_u32 v68, s11, v15
    v_add_u32 v1, 64, v0
    v_mul_u32_u24 v13, 57, v1
    v_lshrrev_b32 v13, 10, v13
    v_mul_u32_u24 v14, 126, v13
    v_add_u32 v14, v14, v1
    v_lshlrev_b32 v165, 4, v14
    v_mul_u32_u24 v14, 18, v13
    v_sub_u32 v1, v1, v14
    v_lshlrev_b32 v138, 3, v1
    v_add_u32 v1, s10, v1
    v_subrev_u32 v14, 144, v1
    v_min_u32 v1, v1, v14
    v_and_b32 v14, 3, v13
    v_add_u32 v14, s12, v14
    v_and_b32 v13, 4, v13
    v_lshrrev_b32 v15, 1, v14
    v_add_u32 v15, v15, v13
    v_lshlrev_b32 v15, 1, v15
    v_xor_b32 v15, v15, v1
    v_and_b32 v15, 15, v15
    v_lshlrev_b32 v15, 3, v15
    v_lshl_add_u32 v15, v14, 7, v15
    v_lshl_add_u32 v15, v13, 8, v15
    v_lshrrev_b32 v1, 4, v1
    v_lshl_add_u32 v15, v1, 13, v15
    v_add_u32 v69, s11, v15
    v_add_u32 v1, 128, v0
    v_mul_u32_u24 v13, 57, v1
    v_lshrrev_b32 v13, 10, v13
    v_mul_u32_u24 v14, 126, v13
    v_add_u32 v14, v14, v1
    v_lshlrev_b32 v166, 4, v14
    v_mul_u32_u24 v14, 18, v13
    v_sub_u32 v1, v1, v14
    v_lshlrev_b32 v142, 3, v1
    v_add_u32 v1, s10, v1
    v_subrev_u32 v14, 144, v1
    v_min_u32 v1, v1, v14
    v_and_b32 v14, 3, v13
    v_add_u32 v14, s12, v14
    v_and_b32 v13, 4, v13
    v_lshrrev_b32 v15, 1, v14
    v_add_u32 v15, v15, v13
    v_lshlrev_b32 v15, 1, v15
    v_xor_b32 v15, v15, v1
    v_and_b32 v15, 15, v15
    v_lshlrev_b32 v15, 3, v15
    v_lshl_add_u32 v15, v14, 7, v15
    v_lshl_add_u32 v15, v13, 8, v15
    v_lshrrev_b32 v1, 4, v1
    v_lshl_add_u32 v15, v1, 13, v15
    v_add_u32 v70, s11, v15
    v_mov_b32 v1, 2146435072
    s_mov_b64 vcc, 0xffff
    v_cndmask_b32 v166, v1, v166, vcc
    s_mul_i32 s9, s4, 144
    s_cmp_lg_u32 s5, 0
    s_cbranch_scc1 nodsk_66
    s_mov_b32 m0, 163584
    s_nop 0
    buffer_load_dword v11, s[68:71], s9 offen lds
nodsk_66:
    s_cmp_ge_u32 s5, 4
    s_cbranch_scc1 L_kv_rest
    s_cmp_ge_u32 s5, 2
    s_cbranch_scc1 L_job_u
    v_bfe_u32 v1, v0, 2, 2
    v_lshl_add_u32 v15, v116, 3, v1
    v_mul_u32_u24 v132, 144, v15
    v_and_b32 v15, 1, v0
    v_lshl_add_u32 v132, v15, 3, v132
    v_add_u32 v132, 94208, v132
    v_bfe_u32 v15, v0, 1, 1
    v_bfe_u32 v13, v0, 4, 1
    v_xor_b32 v14, v15, v13
    v_lshl_add_u32 v108, v14, 18, v132
    v_and_b32 v14, 1, v1
    v_lshl_add_u32 v108, v14, 7, v108
    v_lshl_add_u32 v15, v13, 1, v15
    v_and_b32 v14, 2, v1
    v_add3_u32 v15, v15, v14, 0
    v_and_b32 v15, 7, v15
    v_and_b32 v14, 1, v1
    v_sub_u32 v15, v15, v14
    v_add_u32 v15, 1, v15
    v_lshl_add_u32 v132, v15, 4, v132
    v_and_b32 v1, 7, v0
    v_lshrrev_b32 v15, 2, v1
    v_and_b32 v14, 3, v1
    v_lshl_add_u32 v15, v15, 5, v14
    v_bfe_u32 v1, v0, 3, 2
    v_lshl_add_u32 v144, v1, 2, v15
    v_mul_u32_u24 v144, 148, v144
    v_lshl_add_u32 v144, v116, 3, v144
    s_mul_i32 s8, s82, 2368
    s_add_u32 s8, s8, 148224
    v_add_u32 v144, s8, v144
    v_bfe_u32 v1, v0, 3, 1
    v_lshl_add_u32 v123, v1, 2, v15
    v_lshl_add_u32 v123, v116, 3, v123
    v_mul_u32_u24 v123, 148, v123
    v_lshl_add_u32 v123, v13, 3, v123
    v_add_u32 v123, s8, v123
    s_lshl_b32 s8, s82, 12
    v_add_u32 v128, s8, v128
    v_add_u32 v129, s8, v129
    v_add_u32 v130, s8, v130
    v_add_u32 v131, s8, v131
    s_mov_b32 s15, 0
lw_67:
    ds_read_b32 v1, v135 offset:4
    s_waitcnt lgkmcnt(0)
    v_cmp_gt_u32 vcc, 4, v1
    s_nop 0
    s_cbranch_vccz lwd_68
    s_sleep 0
    s_add_u32 s15, s15, 1
    s_cmp_lt_u32 s15, 0x100000
    s_cbranch_scc1 lw_67
lwd_68:
    ds_read_b128 v[32:35], v128 offset:0
    ds_read_b64_tr_b16 v[36:37], v132 offset:11392
    ds_read_b64_tr_b16 v[38:39], v132 offset:11968
    ds_read_b64_tr_b16 v[40:41], v108 offset:11392
    ds_read_b64_tr_b16 v[42:43], v108 offset:11968
    ds_read_b128 v[44:47], v129 offset:0
    ds_read_b64_tr_b16 v[48:49], v132 offset:13696
    ds_read_b64_tr_b16 v[50:51], v132 offset:14272
    ds_read_b64_tr_b16 v[52:53], v108 offset:13696
    ds_read_b64_tr_b16 v[54:55], v108 offset:14272
    ds_read_b128 v[56:59], v130 offset:0
    ds_read_b64_tr_b16 v[60:61], v132 offset:16000
    ds_read_b64_tr_b16 v[62:63], v132 offset:16576
    ds_read_b64_tr_b16 v[64:65], v108 offset:16000
    ds_read_b64_tr_b16 v[66:67], v108 offset:16576
    s_waitcnt lgkmcnt(10)
    v_mfma_f32_32x32x16_bf16 v[16:31], v[36:39], v[32:35], 0
    v_mfma_f32_16x16x32_bf16 v[148:151], v[40:43], v[32:35], 0
    ds_read_b32 v1, v135 offset:8
    ds_read_b128 v[32:35], v131 offset:0
    ds_read_b64_tr_b16 v[36:37], v132 offset:18304
    ds_read_b64_tr_b16 v[38:39], v132 offset:18880
    ds_read_b64_tr_b16 v[40:41], v108 offset:18304
    ds_read_b64_tr_b16 v[42:43], v108 offset:18880
    s_waitcnt lgkmcnt(5)
    v_cmp_gt_u32 vcc, 4, v1
    v_mfma_f32_32x32x16_bf16 v[16:31], v[48:51], v[44:47], v[16:31]
    v_mfma_f32_16x16x32_bf16 v[148:151], v[52:55], v[44:47], v[148:151]
    s_cbranch_vccnz jslow_69
    ds_read_b128 v[44:47], v128 offset:8192
    ds_read_b64_tr_b16 v[48:49], v132 offset:22784
    ds_read_b64_tr_b16 v[50:51], v132 offset:23360
    ds_read_b64_tr_b16 v[52:53], v108 offset:22784
    ds_read_b64_tr_b16 v[54:55], v108 offset:23360
    v_mfma_f32_32x32x16_bf16 v[16:31], v[60:63], v[56:59], v[16:31]
    v_mfma_f32_16x16x32_bf16 v[148:151], v[64:67], v[56:59], v[148:151]
    ds_read_b128 v[56:59], v129 offset:8192
    ds_read_b64_tr_b16 v[60:61], v132 offset:25088
    ds_read_b64_tr_b16 v[62:63], v132 offset:25664
    ds_read_b64_tr_b16 v[64:65], v108 offset:25088
    ds_read_b64_tr_b16 v[66:67], v108 offset:25664
    s_waitcnt lgkmcnt(10)
    ds_add_u32 v7, v6 offset:128
    v_mfma_f32_32x32x16_bf16 v[16:31], v[36:39], v[32:35], v[16:31]
    v_mfma_f32_16x16x32_bf16 v[148:151], v[40:43], v[32:35], v[148:151]
    ds_read_b128 v[32:35], v130 offset:8192
    ds_read_b64_tr_b16 v[36:37], v132 offset:27392
    ds_read_b64_tr_b16 v[38:39], v132 offset:27968
    ds_read_b64_tr_b16 v[40:41], v108 offset:27392
    ds_read_b64_tr_b16 v[42:43], v108 offset:27968
jret_70:
    s_waitcnt lgkmcnt(10)
    v_mfma_f32_32x32x16_bf16 v[16:31], v[48:51], v[44:47], v[16:31]
    v_mfma_f32_16x16x32_bf16 v[148:151], v[52:55], v[44:47], v[148:151]
    ds_read_b32 v1, v135 offset:12
    ds_read_b128 v[44:47], v131 offset:8192
    ds_read_b64_tr_b16 v[48:49], v132 offset:29696
    ds_read_b64_tr_b16 v[50:51], v132 offset:30272
    ds_read_b64_tr_b16 v[52:53], v108 offset:29696
    ds_read_b64_tr_b16 v[54:55], v108 offset:30272
    s_waitcnt lgkmcnt(5)
    v_cmp_gt_u32 vcc, 4, v1
    v_mfma_f32_32x32x16_bf16 v[16:31], v[60:63], v[56:59], v[16:31]
    v_mfma_f32_16x16x32_bf16 v[148:151], v[64:67], v[56:59], v[148:151]
    s_cbranch_vccnz jslow_73
    ds_read_b128 v[56:59], v128 offset:16384
    ds_read_b64_tr_b16 v[60:61], v132 offset:34176
    ds_read_b64_tr_b16 v[62:63], v132 offset:34752
    ds_read_b64_tr_b16 v[64:65], v108 offset:34176
    ds_read_b64_tr_b16 v[66:67], v108 offset:34752
    v_mfma_f32_32x32x16_bf16 v[16:31], v[36:39], v[32:35], v[16:31]
    v_mfma_f32_16x16x32_bf16 v[148:151], v[40:43], v[32:35], v[148:151]
    ds_read_b128 v[32:35], v129 offset:16384
    ds_read_b64_tr_b16 v[36:37], v132 offset:36480
    ds_read_b64_tr_b16 v[38:39], v132 offset:37056
    ds_read_b64_tr_b16 v[40:41], v108 offset:36480
    ds_read_b64_tr_b16 v[42:43], v108 offset:37056
    s_waitcnt lgkmcnt(10)
    ds_add_u32 v7, v6 offset:128
    v_mfma_f32_32x32x16_bf16 v[16:31], v[48:51], v[44:47], v[16:31]
    v_mfma_f32_16x16x32_bf16 v[148:151], v[52:55], v[44:47], v[148:151]
    ds_read_b128 v[44:47], v130 offset:16384
    ds_read_b64_tr_b16 v[48:49], v132 offset:38784
    ds_read_b64_tr_b16 v[50:51], v132 offset:39360
    ds_read_b64_tr_b16 v[52:53], v108 offset:38784
    ds_read_b64_tr_b16 v[54:55], v108 offset:39360
jret_74:
    s_waitcnt lgkmcnt(10)
    v_mfma_f32_32x32x16_bf16 v[16:31], v[60:63], v[56:59], v[16:31]
    v_mfma_f32_16x16x32_bf16 v[148:151], v[64:67], v[56:59], v[148:151]
    ds_read_b32 v1, v135 offset:16
    ds_read_b128 v[56:59], v131 offset:16384
    ds_read_b64_tr_b16 v[60:61], v132 offset:41088
    ds_read_b64_tr_b16 v[62:63], v132 offset:41664
    ds_read_b64_tr_b16 v[64:65], v108 offset:41088
    ds_read_b64_tr_b16 v[66:67], v108 offset:41664
    s_waitcnt lgkmcnt(5)
    v_cmp_gt_u32 vcc, 4, v1
    v_mfma_f32_32x32x16_bf16 v[16:31], v[36:39], v[32:35], v[16:31]
    v_mfma_f32_16x16x32_bf16 v[148:151], v[40:43], v[32:35], v[148:151]
    s_cbranch_vccnz jslow_77
    ds_read_b128 v[32:35], v128 offset:24576
    ds_read_b64_tr_b16 v[36:37], v132 offset:45568
    ds_read_b64_tr_b16 v[38:39], v132 offset:46144
    ds_read_b64_tr_b16 v[40:41], v108 offset:45568
    ds_read_b64_tr_b16 v[42:43], v108 offset:46144
    v_mfma_f32_32x32x16_bf16 v[16:31], v[48:51], v[44:47], v[16:31]
    v_mfma_f32_16x16x32_bf16 v[148:151], v[52:55], v[44:47], v[148:151]
    ds_read_b128 v[44:47], v129 offset:24576
    ds_read_b64_tr_b16 v[48:49], v132 offset:47872
    ds_read_b64_tr_b16 v[50:51], v132 offset:48448
    ds_read_b64_tr_b16 v[52:53], v108 offset:47872
    ds_read_b64_tr_b16 v[54:55], v108 offset:48448
    s_waitcnt lgkmcnt(10)
    ds_add_u32 v7, v6 offset:128
    v_mfma_f32_32x32x16_bf16 v[16:31], v[60:63], v[56:59], v[16:31]
    v_mfma_f32_16x16x32_bf16 v[148:151], v[64:67], v[56:59], v[148:151]
    ds_read_b128 v[56:59], v130 offset:24576
    ds_read_b64_tr_b16 v[60:61], v132 offset:50176
    ds_read_b64_tr_b16 v[62:63], v132 offset:50752
    ds_read_b64_tr_b16 v[64:65], v108 offset:50176
    ds_read_b64_tr_b16 v[66:67], v108 offset:50752
jret_78:
    s_waitcnt lgkmcnt(10)
    v_mfma_f32_32x32x16_bf16 v[16:31], v[36:39], v[32:35], v[16:31]
    v_mfma_f32_16x16x32_bf16 v[148:151], v[40:43], v[32:35], v[148:151]
    ds_read_b32 v1, v135 offset:20
    ds_read_b128 v[32:35], v131 offset:24576
    ds_read_b64_tr_b16 v[36:37], v132 offset:52480
    ds_read_b64_tr_b16 v[38:39], v132 offset:53056
    ds_read_b64_tr_b16 v[40:41], v108 offset:52480
    ds_read_b64_tr_b16 v[42:43], v108 offset:53056
    s_waitcnt lgkmcnt(5)
    v_cmp_gt_u32 vcc, 4, v1
    v_mfma_f32_32x32x16_bf16 v[16:31], v[48:51], v[44:47], v[16:31]
    v_mfma_f32_16x16x32_bf16 v[148:151], v[52:55], v[44:47], v[148:151]
    s_cbranch_vccnz jslow_81
    ds_read_b128 v[44:47], v128 offset:32768
    ds_read_b64_tr_b16 v[48:49], v132 offset:56960
    ds_read_b64_tr_b16 v[50:51], v132 offset:57536
    ds_read_b64_tr_b16 v[52:53], v108 offset:56960
    ds_read_b64_tr_b16 v[54:55], v108 offset:57536
    v_mfma_f32_32x32x16_bf16 v[16:31], v[60:63], v[56:59], v[16:31]
    v_mfma_f32_16x16x32_bf16 v[148:151], v[64:67], v[56:59], v[148:151]
    ds_read_b128 v[56:59], v129 offset:32768
    ds_read_b64_tr_b16 v[60:61], v132 offset:59264
    ds_read_b64_tr_b16 v[62:63], v132 offset:59840
    ds_read_b64_tr_b16 v[64:65], v108 offset:59264
    ds_read_b64_tr_b16 v[66:67], v108 offset:59840
    s_waitcnt lgkmcnt(10)
    v_mfma_f32_32x32x16_bf16 v[16:31], v[36:39], v[32:35], v[16:31]
    v_mfma_f32_16x16x32_bf16 v[148:151], v[40:43], v[32:35], v[148:151]
    ds_read_b128 v[32:35], v130 offset:32768
    ds_read_b64_tr_b16 v[36:37], v132 offset:61568
    ds_read_b64_tr_b16 v[38:39], v132 offset:62144
    ds_read_b64_tr_b16 v[40:41], v108 offset:61568
    ds_read_b64_tr_b16 v[42:43], v108 offset:62144
jret_82:
    s_waitcnt lgkmcnt(10)
    v_mfma_f32_32x32x16_bf16 v[16:31], v[48:51], v[44:47], v[16:31]
    v_mfma_f32_16x16x32_bf16 v[148:151], v[52:55], v[44:47], v[148:151]
    ds_read_b32 v1, v135 offset:24
    ds_read_b128 v[44:47], v131 offset:32768
    ds_read_b64_tr_b16 v[48:49], v132 offset:63872
    ds_read_b64_tr_b16 v[50:51], v132 offset:64448
    ds_read_b64_tr_b16 v[52:53], v108 offset:63872
    ds_read_b64_tr_b16 v[54:55], v108 offset:64448
    s_waitcnt lgkmcnt(5)
    v_cmp_gt_u32 vcc, 4, v1
    v_mfma_f32_32x32x16_bf16 v[16:31], v[60:63], v[56:59], v[16:31]
    v_mfma_f32_16x16x32_bf16 v[148:151], v[64:67], v[56:59], v[148:151]
    s_cbranch_vccnz jslow_85
    ds_read_b128 v[56:59], v128 offset:40960
    ds_read_b64_tr_b16 v[60:61], v132 offset:0
    ds_read_b64_tr_b16 v[62:63], v132 offset:576
    ds_read_b64_tr_b16 v[64:65], v108 offset:0
    ds_read_b64_tr_b16 v[66:67], v108 offset:576
    v_mfma_f32_32x32x16_bf16 v[16:31], v[36:39], v[32:35], v[16:31]
    v_mfma_f32_16x16x32_bf16 v[148:151], v[40:43], v[32:35], v[148:151]
    ds_read_b128 v[32:35], v129 offset:40960
    ds_read_b64_tr_b16 v[36:37], v132 offset:2304
    ds_read_b64_tr_b16 v[38:39], v132 offset:2880
    ds_read_b64_tr_b16 v[40:41], v108 offset:2304
    ds_read_b64_tr_b16 v[42:43], v108 offset:2880
    s_waitcnt lgkmcnt(10)
    ds_add_u32 v7, v6 offset:128
    v_mfma_f32_32x32x16_bf16 v[16:31], v[48:51], v[44:47], v[16:31]
    v_mfma_f32_16x16x32_bf16 v[148:151], v[52:55], v[44:47], v[148:151]
    ds_read_b128 v[44:47], v130 offset:40960
    ds_read_b64_tr_b16 v[48:49], v132 offset:4608
    ds_read_b64_tr_b16 v[50:51], v132 offset:5184
    ds_read_b64_tr_b16 v[52:53], v108 offset:4608
    ds_read_b64_tr_b16 v[54:55], v108 offset:5184
jret_86:
    s_waitcnt lgkmcnt(10)
    v_mfma_f32_32x32x16_bf16 v[16:31], v[60:63], v[56:59], v[16:31]
    v_mfma_f32_16x16x32_bf16 v[148:151], v[64:67], v[56:59], v[148:151]
    ds_read_b32 v1, v135 offset:28
    ds_read_b128 v[56:59], v131 offset:40960
    ds_read_b64_tr_b16 v[60:61], v132 offset:6912
    ds_read_b64_tr_b16 v[62:63], v132 offset:7488
    ds_read_b64_tr_b16 v[64:65], v108 offset:6912
    ds_read_b64_tr_b16 v[66:67], v108 offset:7488
    s_waitcnt lgkmcnt(5)
    v_cmp_gt_u32 vcc, 4, v1
    v_mfma_f32_32x32x16_bf16 v[16:31], v[36:39], v[32:35], v[16:31]
    v_mfma_f32_16x16x32_bf16 v[148:151], v[40:43], v[32:35], v[148:151]
    s_cbranch_vccnz jslow_89
    ds_read_b128 v[32:35], v128 offset:49152
    ds_read_b64_tr_b16 v[36:37], v132 offset:11392
    ds_read_b64_tr_b16 v[38:39], v132 offset:11968
    ds_read_b64_tr_b16 v[40:41], v108 offset:11392
    ds_read_b64_tr_b16 v[42:43], v108 offset:11968
    v_mfma_f32_32x32x16_bf16 v[16:31], v[48:51], v[44:47], v[16:31]
    v_mfma_f32_16x16x32_bf16 v[148:151], v[52:55], v[44:47], v[148:151]
    ds_read_b128 v[44:47], v129 offset:49152
    ds_read_b64_tr_b16 v[48:49], v132 offset:13696
    ds_read_b64_tr_b16 v[50:51], v132 offset:14272
    ds_read_b64_tr_b16 v[52:53], v108 offset:13696
    ds_read_b64_tr_b16 v[54:55], v108 offset:14272
    s_waitcnt lgkmcnt(10)
    v_mfma_f32_32x32x16_bf16 v[16:31], v[60:63], v[56:59], v[16:31]
    v_mfma_f32_16x16x32_bf16 v[148:151], v[64:67], v[56:59], v[148:151]
    ds_read_b128 v[56:59], v130 offset:49152
    ds_read_b64_tr_b16 v[60:61], v132 offset:16000
    ds_read_b64_tr_b16 v[62:63], v132 offset:16576
    ds_read_b64_tr_b16 v[64:65], v108 offset:16000
    ds_read_b64_tr_b16 v[66:67], v108 offset:16576
jret_90:
    s_waitcnt lgkmcnt(10)
    v_mfma_f32_32x32x16_bf16 v[16:31], v[36:39], v[32:35], v[16:31]
    v_mfma_f32_16x16x32_bf16 v[148:151], v[40:43], v[32:35], v[148:151]
    ds_read_b32 v1, v135 offset:32
    ds_read_b128 v[32:35], v131 offset:49152
    ds_read_b64_tr_b16 v[36:37], v132 offset:18304
    ds_read_b64_tr_b16 v[38:39], v132 offset:18880
    ds_read_b64_tr_b16 v[40:41], v108 offset:18304
    ds_read_b64_tr_b16 v[42:43], v108 offset:18880
    s_waitcnt lgkmcnt(5)
    v_cmp_gt_u32 vcc, 4, v1
    v_mfma_f32_32x32x16_bf16 v[16:31], v[48:51], v[44:47], v[16:31]
    v_mfma_f32_16x16x32_bf16 v[148:151], v[52:55], v[44:47], v[148:151]
    s_cbranch_vccnz jslow_93
    ds_read_b128 v[44:47], v128 offset:57344
    ds_read_b64_tr_b16 v[48:49], v132 offset:22784
    ds_read_b64_tr_b16 v[50:51], v132 offset:23360
    ds_read_b64_tr_b16 v[52:53], v108 offset:22784
    ds_read_b64_tr_b16 v[54:55], v108 offset:23360
    v_mfma_f32_32x32x16_bf16 v[16:31], v[60:63], v[56:59], v[16:31]
    v_mfma_f32_16x16x32_bf16 v[148:151], v[64:67], v[56:59], v[148:151]
    ds_read_b128 v[56:59], v129 offset:57344
    ds_read_b64_tr_b16 v[60:61], v132 offset:25088
    ds_read_b64_tr_b16 v[62:63], v132 offset:25664
    ds_read_b64_tr_b16 v[64:65], v108 offset:25088
    ds_read_b64_tr_b16 v[66:67], v108 offset:25664
    s_waitcnt lgkmcnt(10)
    v_mfma_f32_32x32x16_bf16 v[16:31], v[36:39], v[32:35], v[16:31]
    v_mfma_f32_16x16x32_bf16 v[148:151], v[40:43], v[32:35], v[148:151]
    ds_read_b128 v[32:35], v130 offset:57344
    ds_read_b64_tr_b16 v[36:37], v132 offset:27392
    ds_read_b64_tr_b16 v[38:39], v132 offset:27968
    ds_read_b64_tr_b16 v[40:41], v108 offset:27392
    ds_read_b64_tr_b16 v[42:43], v108 offset:27968
jret_94:
    s_waitcnt lgkmcnt(10)
    v_mfma_f32_32x32x16_bf16 v[16:31], v[48:51], v[44:47], v[16:31]
    v_mfma_f32_16x16x32_bf16 v[148:151], v[52:55], v[44:47], v[148:151]
    ds_read_b32 v1, v135 offset:36
    ds_read_b128 v[44:47], v131 offset:57344
    ds_read_b64_tr_b16 v[48:49], v132 offset:29696
    ds_read_b64_tr_b16 v[50:51], v132 offset:30272
    ds_read_b64_tr_b16 v[52:53], v108 offset:29696
    ds_read_b64_tr_b16 v[54:55], v108 offset:30272
    s_waitcnt lgkmcnt(5)
    v_cmp_gt_u32 vcc, 4, v1
    v_mfma_f32_32x32x16_bf16 v[16:31], v[60:63], v[56:59], v[16:31]
    v_mfma_f32_16x16x32_bf16 v[148:151], v[64:67], v[56:59], v[148:151]
    s_cbranch_vccnz jslow_97
    v_add_u32 v128, 65536, v128
    ds_read_b128 v[56:59], v128 offset:0
    ds_read_b64_tr_b16 v[60:61], v132 offset:34176
    ds_read_b64_tr_b16 v[62:63], v132 offset:34752
    ds_read_b64_tr_b16 v[64:65], v108 offset:34176
    ds_read_b64_tr_b16 v[66:67], v108 offset:34752
    v_mfma_f32_32x32x16_bf16 v[16:31], v[36:39], v[32:35], v[16:31]
    v_mfma_f32_16x16x32_bf16 v[148:151], v[40:43], v[32:35], v[148:151]
    v_add_u32 v129, 65536, v129
    ds_read_b128 v[32:35], v129 offset:0
    ds_read_b64_tr_b16 v[36:37], v132 offset:36480
    ds_read_b64_tr_b16 v[38:39], v132 offset:37056
    ds_read_b64_tr_b16 v[40:41], v108 offset:36480
    ds_read_b64_tr_b16 v[42:43], v108 offset:37056
    s_waitcnt lgkmcnt(10)
    v_mfma_f32_32x32x16_bf16 v[16:31], v[48:51], v[44:47], v[16:31]
    v_mfma_f32_16x16x32_bf16 v[148:151], v[52:55], v[44:47], v[148:151]
    v_add_u32 v130, 65536, v130
    ds_read_b128 v[44:47], v130 offset:0
    ds_read_b64_tr_b16 v[48:49], v132 offset:38784
    ds_read_b64_tr_b16 v[50:51], v132 offset:39360
    ds_read_b64_tr_b16 v[52:53], v108 offset:38784
    ds_read_b64_tr_b16 v[54:55], v108 offset:39360
jret_98:
    s_waitcnt lgkmcnt(10)
    v_mfma_f32_32x32x16_bf16 v[16:31], v[60:63], v[56:59], v[16:31]
    v_mfma_f32_16x16x32_bf16 v[148:151], v[64:67], v[56:59], v[148:151]
    v_add_u32 v131, 65536, v131
    ds_read_b128 v[56:59], v131 offset:0
    ds_read_b64_tr_b16 v[60:61], v132 offset:41088
    ds_read_b64_tr_b16 v[62:63], v132 offset:41664
    ds_read_b64_tr_b16 v[64:65], v108 offset:41088
    ds_read_b64_tr_b16 v[66:67], v108 offset:41664
    s_waitcnt lgkmcnt(10)
    v_mfma_f32_32x32x16_bf16 v[16:31], v[36:39], v[32:35], v[16:31]
    v_mfma_f32_16x16x32_bf16 v[148:151], v[40:43], v[32:35], v[148:151]
    ds_read_b32 v1, v9
    s_waitcnt lgkmcnt(6)
    v_mfma_f32_32x32x16_bf16 v[16:31], v[48:51], v[44:47], v[16:31]
    v_mfma_f32_16x16x32_bf16 v[148:151], v[52:55], v[44:47], v[148:151]
    s_waitcnt lgkmcnt(1)
    v_mfma_f32_32x32x16_bf16 v[16:31], v[60:63], v[56:59], v[16:31]
    v_mfma_f32_16x16x32_bf16 v[148:151], v[64:67], v[56:59], v[148:151]
    s_waitcnt lgkmcnt(0)
    v_cmp_gt_u32 vcc, 4, v1
    s_nop 0
    s_cbranch_vccz jep_101
    s_mov_b32 s15, 0
lw_102:
    ds_read_b32 v1, v9 offset:0
    s_waitcnt lgkmcnt(0)
    v_cmp_gt_u32 vcc, 4, v1
    s_nop 0
    s_cbranch_vccz lwd_103
    s_sleep 0
    s_add_u32 s15, s15, 1
    s_cmp_lt_u32 s15, 0x100000
    s_cbranch_scc1 lw_102
lwd_103:
jep_101:
    s_nop 7
    v_cvt_pk_bf16_f32 v16, v16, v17
    v_cvt_pk_bf16_f32 v17, v18, v19
    ds_write2_b32 v144, v16, v17 offset0:0 offset1:1
    v_cvt_pk_bf16_f32 v20, v20, v21
    v_cvt_pk_bf16_f32 v21, v22, v23
    ds_write2_b32 v144, v20, v21 offset0:4 offset1:5
    v_cvt_pk_bf16_f32 v24, v24, v25
    v_cvt_pk_bf16_f32 v25, v26, v27
    ds_write2_b32 v144, v24, v25 offset0:8 offset1:9
    v_cvt_pk_bf16_f32 v28, v28, v29
    v_cvt_pk_bf16_f32 v29, v30, v31
    ds_write2_b32 v144, v28, v29 offset0:12 offset1:13
    v_cvt_pk_bf16_f32 v148, v148, v149
    v_cvt_pk_bf16_f32 v149, v150, v151
    ds_write2_b32 v123, v148, v149 offset0:32 offset1:33
    s_branch L_pre_done
jslow_69:
    s_waitcnt lgkmcnt(0)
    ds_add_u32 v7, v6 offset:128
    v_mfma_f32_32x32x16_bf16 v[16:31], v[60:63], v[56:59], v[16:31]
    v_mfma_f32_16x16x32_bf16 v[148:151], v[64:67], v[56:59], v[148:151]
    v_mfma_f32_32x32x16_bf16 v[16:31], v[36:39], v[32:35], v[16:31]
    v_mfma_f32_16x16x32_bf16 v[148:151], v[40:43], v[32:35], v[148:151]
    s_mov_b32 s15, 0
js_71:
    ds_read_b32 v1, v135 offset:8
    ds_read_b128 v[44:47], v128 offset:8192
    ds_read_b64_tr_b16 v[48:49], v132 offset:22784
    ds_read_b64_tr_b16 v[50:51], v132 offset:23360
    ds_read_b64_tr_b16 v[52:53], v108 offset:22784
    ds_read_b64_tr_b16 v[54:55], v108 offset:23360
    s_waitcnt lgkmcnt(5)
    v_cmp_gt_u32 vcc, 4, v1
    s_nop 0
    s_cbranch_vccz jsd_72
    s_add_u32 s15, s15, 1
    s_cmp_lt_u32 s15, 0x100000
    s_cbranch_scc1 js_71
jsd_72:
    ds_read_b128 v[56:59], v129 offset:8192
    ds_read_b64_tr_b16 v[60:61], v132 offset:25088
    ds_read_b64_tr_b16 v[62:63], v132 offset:25664
    ds_read_b64_tr_b16 v[64:65], v108 offset:25088
    ds_read_b64_tr_b16 v[66:67], v108 offset:25664
    ds_read_b128 v[32:35], v130 offset:8192
    ds_read_b64_tr_b16 v[36:37], v132 offset:27392
    ds_read_b64_tr_b16 v[38:39], v132 offset:27968
    ds_read_b64_tr_b16 v[40:41], v108 offset:27392
    ds_read_b64_tr_b16 v[42:43], v108 offset:27968
    s_branch jret_70
jslow_73:
    s_waitcnt lgkmcnt(0)
    ds_add_u32 v7, v6 offset:128
    v_mfma_f32_32x32x16_bf16 v[16:31], v[36:39], v[32:35], v[16:31]
    v_mfma_f32_16x16x32_bf16 v[148:151], v[40:43], v[32:35], v[148:151]
    v_mfma_f32_32x32x16_bf16 v[16:31], v[48:51], v[44:47], v[16:31]
    v_mfma_f32_16x16x32_bf16 v[148:151], v[52:55], v[44:47], v[148:151]
    s_mov_b32 s15, 0
js_75:
    ds_read_b32 v1, v135 offset:12
    ds_read_b128 v[56:59], v128 offset:16384
    ds_read_b64_tr_b16 v[60:61], v132 offset:34176
    ds_read_b64_tr_b16 v[62:63], v132 offset:34752
    ds_read_b64_tr_b16 v[64:65], v108 offset:34176
    ds_read_b64_tr_b16 v[66:67], v108 offset:34752
    s_waitcnt lgkmcnt(5)
    v_cmp_gt_u32 vcc, 4, v1
    s_nop 0
    s_cbranch_vccz jsd_76
    s_add_u32 s15, s15, 1
    s_cmp_lt_u32 s15, 0x100000
    s_cbranch_scc1 js_75
jsd_76:
    ds_read_b128 v[32:35], v129 offset:16384
    ds_read_b64_tr_b16 v[36:37], v132 offset:36480
    ds_read_b64_tr_b16 v[38:39], v132 offset:37056
    ds_read_b64_tr_b16 v[40:41], v108 offset:36480
    ds_read_b64_tr_b16 v[42:43], v108 offset:37056
    ds_read_b128 v[44:47], v130 offset:16384
    ds_read_b64_tr_b16 v[48:49], v132 offset:38784
    ds_read_b64_tr_b16 v[50:51], v132 offset:39360
    ds_read_b64_tr_b16 v[52:53], v108 offset:38784
    ds_read_b64_tr_b16 v[54:55], v108 offset:39360
    s_branch jret_74
jslow_77:
    s_waitcnt lgkmcnt(0)
    ds_add_u32 v7, v6 offset:128
    v_mfma_f32_32x32x16_bf16 v[16:31], v[48:51], v[44:47], v[16:31]
    v_mfma_f32_16x16x32_bf16 v[148:151], v[52:55], v[44:47], v[148:151]
    v_mfma_f32_32x32x16_bf16 v[16:31], v[60:63], v[56:59], v[16:31]
    v_mfma_f32_16x16x32_bf16 v[148:151], v[64:67], v[56:59], v[148:151]
    s_mov_b32 s15, 0
js_79:
    ds_read_b32 v1, v135 offset:16
    ds_read_b128 v[32:35], v128 offset:24576
    ds_read_b64_tr_b16 v[36:37], v132 offset:45568
    ds_read_b64_tr_b16 v[38:39], v132 offset:46144
    ds_read_b64_tr_b16 v[40:41], v108 offset:45568
    ds_read_b64_tr_b16 v[42:43], v108 offset:46144
    s_waitcnt lgkmcnt(5)
    v_cmp_gt_u32 vcc, 4, v1
    s_nop 0
    s_cbranch_vccz jsd_80
    s_add_u32 s15, s15, 1
    s_cmp_lt_u32 s15, 0x100000
    s_cbranch_scc1 js_79
jsd_80:
    ds_read_b128 v[44:47], v129 offset:24576
    ds_read_b64_tr_b16 v[48:49], v132 offset:47872
    ds_read_b64_tr_b16 v[50:51], v132 offset:48448
    ds_read_b64_tr_b16 v[52:53], v108 offset:47872
    ds_read_b64_tr_b16 v[54:55], v108 offset:48448
    ds_read_b128 v[56:59], v130 offset:24576
    ds_read_b64_tr_b16 v[60:61], v132 offset:50176
    ds_read_b64_tr_b16 v[62:63], v132 offset:50752
    ds_read_b64_tr_b16 v[64:65], v108 offset:50176
    ds_read_b64_tr_b16 v[66:67], v108 offset:50752
    s_branch jret_78
jslow_81:
    s_waitcnt lgkmcnt(0)
    v_mfma_f32_32x32x16_bf16 v[16:31], v[60:63], v[56:59], v[16:31]
    v_mfma_f32_16x16x32_bf16 v[148:151], v[64:67], v[56:59], v[148:151]
    v_mfma_f32_32x32x16_bf16 v[16:31], v[36:39], v[32:35], v[16:31]
    v_mfma_f32_16x16x32_bf16 v[148:151], v[40:43], v[32:35], v[148:151]
    s_mov_b32 s15, 0
js_83:
    ds_read_b32 v1, v135 offset:20
    ds_read_b128 v[44:47], v128 offset:32768
    ds_read_b64_tr_b16 v[48:49], v132 offset:56960
    ds_read_b64_tr_b16 v[50:51], v132 offset:57536
    ds_read_b64_tr_b16 v[52:53], v108 offset:56960
    ds_read_b64_tr_b16 v[54:55], v108 offset:57536
    s_waitcnt lgkmcnt(5)
    v_cmp_gt_u32 vcc, 4, v1
    s_nop 0
    s_cbranch_vccz jsd_84
    s_add_u32 s15, s15, 1
    s_cmp_lt_u32 s15, 0x100000
    s_cbranch_scc1 js_83
jsd_84:
    ds_read_b128 v[56:59], v129 offset:32768
    ds_read_b64_tr_b16 v[60:61], v132 offset:59264
    ds_read_b64_tr_b16 v[62:63], v132 offset:59840
    ds_read_b64_tr_b16 v[64:65], v108 offset:59264
    ds_read_b64_tr_b16 v[66:67], v108 offset:59840
    ds_read_b128 v[32:35], v130 offset:32768
    ds_read_b64_tr_b16 v[36:37], v132 offset:61568
    ds_read_b64_tr_b16 v[38:39], v132 offset:62144
    ds_read_b64_tr_b16 v[40:41], v108 offset:61568
    ds_read_b64_tr_b16 v[42:43], v108 offset:62144
    s_branch jret_82
jslow_85:
    s_waitcnt lgkmcnt(0)
    ds_add_u32 v7, v6 offset:128
    v_mfma_f32_32x32x16_bf16 v[16:31], v[36:39], v[32:35], v[16:31]
    v_mfma_f32_16x16x32_bf16 v[148:151], v[40:43], v[32:35], v[148:151]
    v_mfma_f32_32x32x16_bf16 v[16:31], v[48:51], v[44:47], v[16:31]
    v_mfma_f32_16x16x32_bf16 v[148:151], v[52:55], v[44:47], v[148:151]
    s_mov_b32 s15, 0
js_87:
    ds_read_b32 v1, v135 offset:24
    ds_read_b128 v[56:59], v128 offset:40960
    ds_read_b64_tr_b16 v[60:61], v132 offset:0
    ds_read_b64_tr_b16 v[62:63], v132 offset:576
    ds_read_b64_tr_b16 v[64:65], v108 offset:0
    ds_read_b64_tr_b16 v[66:67], v108 offset:576
    s_waitcnt lgkmcnt(5)
    v_cmp_gt_u32 vcc, 4, v1
    s_nop 0
    s_cbranch_vccz jsd_88
    s_add_u32 s15, s15, 1
    s_cmp_lt_u32 s15, 0x100000
    s_cbranch_scc1 js_87
jsd_88:
    ds_read_b128 v[32:35], v129 offset:40960
    ds_read_b64_tr_b16 v[36:37], v132 offset:2304
    ds_read_b64_tr_b16 v[38:39], v132 offset:2880
    ds_read_b64_tr_b16 v[40:41], v108 offset:2304
    ds_read_b64_tr_b16 v[42:43], v108 offset:2880
    ds_read_b128 v[44:47], v130 offset:40960
    ds_read_b64_tr_b16 v[48:49], v132 offset:4608
    ds_read_b64_tr_b16 v[50:51], v132 offset:5184
    ds_read_b64_tr_b16 v[52:53], v108 offset:4608
    ds_read_b64_tr_b16 v[54:55], v108 offset:5184
    s_branch jret_86
jslow_89:
    s_waitcnt lgkmcnt(0)
    v_mfma_f32_32x32x16_bf16 v[16:31], v[48:51], v[44:47], v[16:31]
    v_mfma_f32_16x16x32_bf16 v[148:151], v[52:55], v[44:47], v[148:151]
    v_mfma_f32_32x32x16_bf16 v[16:31], v[60:63], v[56:59], v[16:31]
    v_mfma_f32_16x16x32_bf16 v[148:151], v[64:67], v[56:59], v[148:151]
    s_mov_b32 s15, 0
js_91:
    ds_read_b32 v1, v135 offset:28
    ds_read_b128 v[32:35], v128 offset:49152
    ds_read_b64_tr_b16 v[36:37], v132 offset:11392
    ds_read_b64_tr_b16 v[38:39], v132 offset:11968
    ds_read_b64_tr_b16 v[40:41], v108 offset:11392
    ds_read_b64_tr_b16 v[42:43], v108 offset:11968
    s_waitcnt lgkmcnt(5)
    v_cmp_gt_u32 vcc, 4, v1
    s_nop 0
    s_cbranch_vccz jsd_92
    s_add_u32 s15, s15, 1
    s_cmp_lt_u32 s15, 0x100000
    s_cbranch_scc1 js_91
jsd_92:
    ds_read_b128 v[44:47], v129 offset:49152
    ds_read_b64_tr_b16 v[48:49], v132 offset:13696
    ds_read_b64_tr_b16 v[50:51], v132 offset:14272
    ds_read_b64_tr_b16 v[52:53], v108 offset:13696
    ds_read_b64_tr_b16 v[54:55], v108 offset:14272
    ds_read_b128 v[56:59], v130 offset:49152
    ds_read_b64_tr_b16 v[60:61], v132 offset:16000
    ds_read_b64_tr_b16 v[62:63], v132 offset:16576
    ds_read_b64_tr_b16 v[64:65], v108 offset:16000
    ds_read_b64_tr_b16 v[66:67], v108 offset:16576
    s_branch jret_90
jslow_93:
    s_waitcnt lgkmcnt(0)
    v_mfma_f32_32x32x16_bf16 v[16:31], v[60:63], v[56:59], v[16:31]
    v_mfma_f32_16x16x32_bf16 v[148:151], v[64:67], v[56:59], v[148:151]
    v_mfma_f32_32x32x16_bf16 v[16:31], v[36:39], v[32:35], v[16:31]
    v_mfma_f32_16x16x32_bf16 v[148:151], v[40:43], v[32:35], v[148:151]
    s_mov_b32 s15, 0
js_95:
    ds_read_b32 v1, v135 offset:32
    ds_read_b128 v[44:47], v128 offset:57344
    ds_read_b64_tr_b16 v[48:49], v132 offset:22784
    ds_read_b64_tr_b16 v[50:51], v132 offset:23360
    ds_read_b64_tr_b16 v[52:53], v108 offset:22784
    ds_read_b64_tr_b16 v[54:55], v108 offset:23360
    s_waitcnt lgkmcnt(5)
    v_cmp_gt_u32 vcc, 4, v1
    s_nop 0
    s_cbranch_vccz jsd_96
    s_add_u32 s15, s15, 1
    s_cmp_lt_u32 s15, 0x100000
    s_cbranch_scc1 js_95
jsd_96:
    ds_read_b128 v[56:59], v129 offset:57344
    ds_read_b64_tr_b16 v[60:61], v132 offset:25088
    ds_read_b64_tr_b16 v[62:63], v132 offset:25664
    ds_read_b64_tr_b16 v[64:65], v108 offset:25088
    ds_read_b64_tr_b16 v[66:67], v108 offset:25664
    ds_read_b128 v[32:35], v130 offset:57344
    ds_read_b64_tr_b16 v[36:37], v132 offset:27392
    ds_read_b64_tr_b16 v[38:39], v132 offset:27968
    ds_read_b64_tr_b16 v[40:41], v108 offset:27392
    ds_read_b64_tr_b16 v[42:43], v108 offset:27968
    s_branch jret_94
jslow_97:
    s_waitcnt lgkmcnt(0)
    v_mfma_f32_32x32x16_bf16 v[16:31], v[36:39], v[32:35], v[16:31]
    v_mfma_f32_16x16x32_bf16 v[148:151], v[40:43], v[32:35], v[148:151]
    v_mfma_f32_32x32x16_bf16 v[16:31], v[48:51], v[44:47], v[16:31]
    v_mfma_f32_16x16x32_bf16 v[148:151], v[52:55], v[44:47], v[148:151]
    v_add_u32 v128, 65536, v128
    s_mov_b32 s15, 0
js_99:
    ds_read_b32 v1, v135 offset:36
    ds_read_b128 v[56:59], v128 offset:0
    ds_read_b64_tr_b16 v[60:61], v132 offset:34176
    ds_read_b64_tr_b16 v[62:63], v132 offset:34752
    ds_read_b64_tr_b16 v[64:65], v108 offset:34176
    ds_read_b64_tr_b16 v[66:67], v108 offset:34752
    s_waitcnt lgkmcnt(5)
    v_cmp_gt_u32 vcc, 4, v1
    s_nop 0
    s_cbranch_vccz jsd_100
    s_add_u32 s15, s15, 1
    s_cmp_lt_u32 s15, 0x100000
    s_cbranch_scc1 js_99
jsd_100:
    v_add_u32 v129, 65536, v129
    ds_read_b128 v[32:35], v129 offset:0
    ds_read_b64_tr_b16 v[36:37], v132 offset:36480
    ds_read_b64_tr_b16 v[38:39], v132 offset:37056
    ds_read_b64_tr_b16 v[40:41], v108 offset:36480
    ds_read_b64_tr_b16 v[42:43], v108 offset:37056
    v_add_u32 v130, 65536, v130
    ds_read_b128 v[44:47], v130 offset:0
    ds_read_b64_tr_b16 v[48:49], v132 offset:38784
    ds_read_b64_tr_b16 v[50:51], v132 offset:39360
    ds_read_b64_tr_b16 v[52:53], v108 offset:38784
    ds_read_b64_tr_b16 v[54:55], v108 offset:39360
    s_branch jret_98
L_job_u:
    v_bfe_u32 v1, v0, 2, 2
    v_lshl_add_u32 v15, v116, 3, v1
    v_mul_u32_u24 v132, 144, v15
    v_and_b32 v15, 1, v0
    v_lshl_add_u32 v132, v15, 3, v132
    v_add_u32 v132, 94208, v132
    v_bfe_u32 v15, v0, 1, 1
    v_bfe_u32 v13, v0, 4, 1
    v_lshl_add_u32 v15, v13, 1, v15
    v_and_b32 v14, 2, v1
    v_add3_u32 v15, v15, v14, 4
    v_and_b32 v15, 7, v15
    v_and_b32 v14, 1, v1
    v_sub_u32 v15, v15, v14
    v_add_u32 v15, 1, v15
    v_lshl_add_u32 v132, v15, 4, v132
    v_and_b32 v1, 7, v0
    v_lshrrev_b32 v15, 2, v1
    v_and_b32 v14, 3, v1
    v_lshl_add_u32 v15, v15, 5, v14
    v_bfe_u32 v1, v0, 3, 2
    v_lshl_add_u32 v144, v1, 2, v15
    v_mul_u32_u24 v144, 148, v144
    v_lshl_add_u32 v144, v116, 3, v144
    s_mul_i32 s8, s82, 2368
    s_add_u32 s8, s8, 148288
    v_add_u32 v144, s8, v144
    v_and_b32 v1, 1, v0
    v_bfe_u32 v14, v0, 1, 3
    v_lshlrev_b32 v108, 10, v1
    v_lshl_add_u32 v108, v14, 7, v108
    v_lshrrev_b32 v14, 1, v14
    v_lshl_or_b32 v14, v1, 2, v14
    v_xor_b32 v14, v14, v116
    v_lshl_add_u32 v108, v14, 4, v108
    v_add_u32 v14, 2048, v108
    v_mul_u32_u24 v123, 272, v117
    v_add_u32 v123, 157696, v123
    v_mov_b32 v1, 162816
    v_cmp_eq_u32 vcc, 16, v117
    s_nop 1
    v_cndmask_b32 v108, v108, v14, vcc
    v_cndmask_b32 v123, v123, v1, vcc
    v_cmp_lt_u32 vcc, 16, v117
    s_nop 1
    v_cndmask_b32 v108, v108, v118, vcc
    v_cndmask_b32 v123, v123, v118, vcc
    v_add_u32 v108, 103424, v108
    v_lshl_add_u32 v123, v116, 7, v123
    s_lshl_b32 s8, s82, 6
    v_add_u32 v123, s8, v123
    v_xor_b32 v109, 32, v108
    v_xor_b32 v110, 64, v108
    v_xor_b32 v111, 96, v108
    s_lshl_b32 s8, s82, 12
    v_add_u32 v128, s8, v128
    v_add_u32 v129, s8, v129
    v_add_u32 v130, s8, v130
    v_add_u32 v131, s8, v131
    s_mov_b32 s15, 0
lw_104:
    ds_read_b32 v1, v135 offset:4
    s_waitcnt lgkmcnt(0)
    v_cmp_gt_u32 vcc, 4, v1
    s_nop 0
    s_cbranch_vccz lwd_105
    s_sleep 0
    s_add_u32 s15, s15, 1
    s_cmp_lt_u32 s15, 0x100000
    s_cbranch_scc1 lw_104
lwd_105:
    ds_read_b128 v[32:35], v128 offset:0
    ds_read_b64_tr_b16 v[36:37], v132 offset:11392
    ds_read_b64_tr_b16 v[38:39], v132 offset:11968
    ds_read_b128 v[40:43], v108 offset:11392
    ds_read_b128 v[44:47], v129 offset:0
    ds_read_b64_tr_b16 v[48:49], v132 offset:13696
    ds_read_b64_tr_b16 v[50:51], v132 offset:14272
    ds_read_b128 v[52:55], v109 offset:11392
    ds_read_b128 v[56:59], v130 offset:0
    ds_read_b64_tr_b16 v[60:61], v132 offset:16000
    ds_read_b64_tr_b16 v[62:63], v132 offset:16576
    ds_read_b128 v[64:67], v110 offset:11392
    s_waitcnt lgkmcnt(8)
    v_mfma_f32_32x32x16_bf16 v[16:31], v[36:39], v[32:35], 0
    v_mfma_f32_32x32x16_bf16 v[148:163], v[32:35], v[40:43], 0
    ds_read_b32 v1, v135 offset:8
    ds_read_b128 v[32:35], v131 offset:0
    ds_read_b64_tr_b16 v[36:37], v132 offset:18304
    ds_read_b64_tr_b16 v[38:39], v132 offset:18880
    ds_read_b128 v[40:43], v111 offset:11392
    s_waitcnt lgkmcnt(4)
    v_cmp_gt_u32 vcc, 4, v1
    v_mfma_f32_32x32x16_bf16 v[16:31], v[48:51], v[44:47], v[16:31]
    v_mfma_f32_32x32x16_bf16 v[148:163], v[44:47], v[52:55], v[148:163]
    s_cbranch_vccnz jslow_106
    ds_read_b128 v[44:47], v128 offset:8192
    ds_read_b64_tr_b16 v[48:49], v132 offset:22784
    ds_read_b64_tr_b16 v[50:51], v132 offset:23360
    ds_read_b128 v[52:55], v108 offset:22784
    v_mfma_f32_32x32x16_bf16 v[16:31], v[60:63], v[56:59], v[16:31]
    v_mfma_f32_32x32x16_bf16 v[148:163], v[56:59], v[64:67], v[148:163]
    ds_read_b128 v[56:59], v129 offset:8192
    ds_read_b64_tr_b16 v[60:61], v132 offset:25088
    ds_read_b64_tr_b16 v[62:63], v132 offset:25664
    ds_read_b128 v[64:67], v109 offset:22784
    s_waitcnt lgkmcnt(8)
    ds_add_u32 v7, v6 offset:128
    v_mfma_f32_32x32x16_bf16 v[16:31], v[36:39], v[32:35], v[16:31]
    v_mfma_f32_32x32x16_bf16 v[148:163], v[32:35], v[40:43], v[148:163]
    ds_read_b128 v[32:35], v130 offset:8192
    ds_read_b64_tr_b16 v[36:37], v132 offset:27392
    ds_read_b64_tr_b16 v[38:39], v132 offset:27968
    ds_read_b128 v[40:43], v110 offset:22784
jret_107:
    s_waitcnt lgkmcnt(8)
    v_mfma_f32_32x32x16_bf16 v[16:31], v[48:51], v[44:47], v[16:31]
    v_mfma_f32_32x32x16_bf16 v[148:163], v[44:47], v[52:55], v[148:163]
    ds_read_b32 v1, v135 offset:12
    ds_read_b128 v[44:47], v131 offset:8192
    ds_read_b64_tr_b16 v[48:49], v132 offset:29696
    ds_read_b64_tr_b16 v[50:51], v132 offset:30272
    ds_read_b128 v[52:55], v111 offset:22784
    s_waitcnt lgkmcnt(4)
    v_cmp_gt_u32 vcc, 4, v1
    v_mfma_f32_32x32x16_bf16 v[16:31], v[60:63], v[56:59], v[16:31]
    v_mfma_f32_32x32x16_bf16 v[148:163], v[56:59], v[64:67], v[148:163]
    s_cbranch_vccnz jslow_110
    ds_read_b128 v[56:59], v128 offset:16384
    ds_read_b64_tr_b16 v[60:61], v132 offset:34176
    ds_read_b64_tr_b16 v[62:63], v132 offset:34752
    ds_read_b128 v[64:67], v108 offset:34176
    v_mfma_f32_32x32x16_bf16 v[16:31], v[36:39], v[32:35], v[16:31]
    v_mfma_f32_32x32x16_bf16 v[148:163], v[32:35], v[40:43], v[148:163]
    ds_read_b128 v[32:35], v129 offset:16384
    ds_read_b64_tr_b16 v[36:37], v132 offset:36480
    ds_read_b64_tr_b16 v[38:39], v132 offset:37056
    ds_read_b128 v[40:43], v109 offset:34176
    s_waitcnt lgkmcnt(8)
    ds_add_u32 v7, v6 offset:128
    v_mfma_f32_32x32x16_bf16 v[16:31], v[48:51], v[44:47], v[16:31]
    v_mfma_f32_32x32x16_bf16 v[148:163], v[44:47], v[52:55], v[148:163]
    ds_read_b128 v[44:47], v130 offset:16384
    ds_read_b64_tr_b16 v[48:49], v132 offset:38784
    ds_read_b64_tr_b16 v[50:51], v132 offset:39360
    ds_read_b128 v[52:55], v110 offset:34176
jret_111:
    s_waitcnt lgkmcnt(8)
    v_mfma_f32_32x32x16_bf16 v[16:31], v[60:63], v[56:59], v[16:31]
    v_mfma_f32_32x32x16_bf16 v[148:163], v[56:59], v[64:67], v[148:163]
    ds_read_b32 v1, v135 offset:16
    ds_read_b128 v[56:59], v131 offset:16384
    ds_read_b64_tr_b16 v[60:61], v132 offset:41088
    ds_read_b64_tr_b16 v[62:63], v132 offset:41664
    ds_read_b128 v[64:67], v111 offset:34176
    s_waitcnt lgkmcnt(4)
    v_cmp_gt_u32 vcc, 4, v1
    v_mfma_f32_32x32x16_bf16 v[16:31], v[36:39], v[32:35], v[16:31]
    v_mfma_f32_32x32x16_bf16 v[148:163], v[32:35], v[40:43], v[148:163]
    s_cbranch_vccnz jslow_114
    ds_read_b128 v[32:35], v128 offset:24576
    ds_read_b64_tr_b16 v[36:37], v132 offset:45568
    ds_read_b64_tr_b16 v[38:39], v132 offset:46144
    ds_read_b128 v[40:43], v108 offset:45568
    v_mfma_f32_32x32x16_bf16 v[16:31], v[48:51], v[44:47], v[16:31]
    v_mfma_f32_32x32x16_bf16 v[148:163], v[44:47], v[52:55], v[148:163]
    ds_read_b128 v[44:47], v129 offset:24576
    ds_read_b64_tr_b16 v[48:49], v132 offset:47872
    ds_read_b64_tr_b16 v[50:51], v132 offset:48448
    ds_read_b128 v[52:55], v109 offset:45568
    s_waitcnt lgkmcnt(8)
    ds_add_u32 v7, v6 offset:128
    v_mfma_f32_32x32x16_bf16 v[16:31], v[60:63], v[56:59], v[16:31]
    v_mfma_f32_32x32x16_bf16 v[148:163], v[56:59], v[64:67], v[148:163]
    ds_read_b128 v[56:59], v130 offset:24576
    ds_read_b64_tr_b16 v[60:61], v132 offset:50176
    ds_read_b64_tr_b16 v[62:63], v132 offset:50752
    ds_read_b128 v[64:67], v110 offset:45568
jret_115:
    s_waitcnt lgkmcnt(8)
    v_mfma_f32_32x32x16_bf16 v[16:31], v[36:39], v[32:35], v[16:31]
    v_mfma_f32_32x32x16_bf16 v[148:163], v[32:35], v[40:43], v[148:163]
    ds_read_b32 v1, v135 offset:20
    ds_read_b128 v[32:35], v131 offset:24576
    ds_read_b64_tr_b16 v[36:37], v132 offset:52480
    ds_read_b64_tr_b16 v[38:39], v132 offset:53056
    ds_read_b128 v[40:43], v111 offset:45568
    s_waitcnt lgkmcnt(4)
    v_cmp_gt_u32 vcc, 4, v1
    v_mfma_f32_32x32x16_bf16 v[16:31], v[48:51], v[44:47], v[16:31]
    v_mfma_f32_32x32x16_bf16 v[148:163], v[44:47], v[52:55], v[148:163]
    s_cbranch_vccnz jslow_118
    ds_read_b128 v[44:47], v128 offset:32768
    ds_read_b64_tr_b16 v[48:49], v132 offset:56960
    ds_read_b64_tr_b16 v[50:51], v132 offset:57536
    ds_read_b128 v[52:55], v108 offset:56960
    v_mfma_f32_32x32x16_bf16 v[16:31], v[60:63], v[56:59], v[16:31]
    v_mfma_f32_32x32x16_bf16 v[148:163], v[56:59], v[64:67], v[148:163]
    ds_read_b128 v[56:59], v129 offset:32768
    ds_read_b64_tr_b16 v[60:61], v132 offset:59264
    ds_read_b64_tr_b16 v[62:63], v132 offset:59840
    ds_read_b128 v[64:67], v109 offset:56960
    s_waitcnt lgkmcnt(8)
    v_mfma_f32_32x32x16_bf16 v[16:31], v[36:39], v[32:35], v[16:31]
    v_mfma_f32_32x32x16_bf16 v[148:163], v[32:35], v[40:43], v[148:163]
    ds_read_b128 v[32:35], v130 offset:32768
    ds_read_b64_tr_b16 v[36:37], v132 offset:61568
    ds_read_b64_tr_b16 v[38:39], v132 offset:62144
    ds_read_b128 v[40:43], v110 offset:56960
jret_119:
    s_waitcnt lgkmcnt(8)
    v_mfma_f32_32x32x16_bf16 v[16:31], v[48:51], v[44:47], v[16:31]
    v_mfma_f32_32x32x16_bf16 v[148:163], v[44:47], v[52:55], v[148:163]
    ds_read_b32 v1, v135 offset:24
    ds_read_b128 v[44:47], v131 offset:32768
    ds_read_b64_tr_b16 v[48:49], v132 offset:63872
    ds_read_b64_tr_b16 v[50:51], v132 offset:64448
    ds_read_b128 v[52:55], v111 offset:56960
    s_waitcnt lgkmcnt(4)
    v_cmp_gt_u32 vcc, 4, v1
    v_mfma_f32_32x32x16_bf16 v[16:31], v[60:63], v[56:59], v[16:31]
    v_mfma_f32_32x32x16_bf16 v[148:163], v[56:59], v[64:67], v[148:163]
    s_cbranch_vccnz jslow_122
    ds_read_b128 v[56:59], v128 offset:40960
    ds_read_b64_tr_b16 v[60:61], v132 offset:0
    ds_read_b64_tr_b16 v[62:63], v132 offset:576
    ds_read_b128 v[64:67], v108 offset:0
    v_mfma_f32_32x32x16_bf16 v[16:31], v[36:39], v[32:35], v[16:31]
    v_mfma_f32_32x32x16_bf16 v[148:163], v[32:35], v[40:43], v[148:163]
    ds_read_b128 v[32:35], v129 offset:40960
    ds_read_b64_tr_b16 v[36:37], v132 offset:2304
    ds_read_b64_tr_b16 v[38:39], v132 offset:2880
    ds_read_b128 v[40:43], v109 offset:0
    s_waitcnt lgkmcnt(8)
    ds_add_u32 v7, v6 offset:128
    v_mfma_f32_32x32x16_bf16 v[16:31], v[48:51], v[44:47], v[16:31]
    v_mfma_f32_32x32x16_bf16 v[148:163], v[44:47], v[52:55], v[148:163]
    ds_read_b128 v[44:47], v130 offset:40960
    ds_read_b64_tr_b16 v[48:49], v132 offset:4608
    ds_read_b64_tr_b16 v[50:51], v132 offset:5184
    ds_read_b128 v[52:55], v110 offset:0
jret_123:
    s_waitcnt lgkmcnt(8)
    v_mfma_f32_32x32x16_bf16 v[16:31], v[60:63], v[56:59], v[16:31]
    v_mfma_f32_32x32x16_bf16 v[148:163], v[56:59], v[64:67], v[148:163]
    ds_read_b32 v1, v135 offset:28
    ds_read_b128 v[56:59], v131 offset:40960
    ds_read_b64_tr_b16 v[60:61], v132 offset:6912
    ds_read_b64_tr_b16 v[62:63], v132 offset:7488
    ds_read_b128 v[64:67], v111 offset:0
    s_waitcnt lgkmcnt(4)
    v_cmp_gt_u32 vcc, 4, v1
    v_mfma_f32_32x32x16_bf16 v[16:31], v[36:39], v[32:35], v[16:31]
    v_mfma_f32_32x32x16_bf16 v[148:163], v[32:35], v[40:43], v[148:163]
    s_cbranch_vccnz jslow_126
    ds_read_b128 v[32:35], v128 offset:49152
    ds_read_b64_tr_b16 v[36:37], v132 offset:11392
    ds_read_b64_tr_b16 v[38:39], v132 offset:11968
    ds_read_b128 v[40:43], v108 offset:11392
    v_mfma_f32_32x32x16_bf16 v[16:31], v[48:51], v[44:47], v[16:31]
    v_mfma_f32_32x32x16_bf16 v[148:163], v[44:47], v[52:55], v[148:163]
    ds_read_b128 v[44:47], v129 offset:49152
    ds_read_b64_tr_b16 v[48:49], v132 offset:13696
    ds_read_b64_tr_b16 v[50:51], v132 offset:14272
    ds_read_b128 v[52:55], v109 offset:11392
    s_waitcnt lgkmcnt(8)
    v_mfma_f32_32x32x16_bf16 v[16:31], v[60:63], v[56:59], v[16:31]
    v_mfma_f32_32x32x16_bf16 v[148:163], v[56:59], v[64:67], v[148:163]
    ds_read_b128 v[56:59], v130 offset:49152
    ds_read_b64_tr_b16 v[60:61], v132 offset:16000
    ds_read_b64_tr_b16 v[62:63], v132 offset:16576
    ds_read_b128 v[64:67], v110 offset:11392
jret_127:
    s_waitcnt lgkmcnt(8)
    v_mfma_f32_32x32x16_bf16 v[16:31], v[36:39], v[32:35], v[16:31]
    v_mfma_f32_32x32x16_bf16 v[148:163], v[32:35], v[40:43], v[148:163]
    ds_read_b32 v1, v135 offset:32
    ds_read_b128 v[32:35], v131 offset:49152
    ds_read_b64_tr_b16 v[36:37], v132 offset:18304
    ds_read_b64_tr_b16 v[38:39], v132 offset:18880
    ds_read_b128 v[40:43], v111 offset:11392
    s_waitcnt lgkmcnt(4)
    v_cmp_gt_u32 vcc, 4, v1
    v_mfma_f32_32x32x16_bf16 v[16:31], v[48:51], v[44:47], v[16:31]
    v_mfma_f32_32x32x16_bf16 v[148:163], v[44:47], v[52:55], v[148:163]
    s_cbranch_vccnz jslow_130
    ds_read_b128 v[44:47], v128 offset:57344
    ds_read_b64_tr_b16 v[48:49], v132 offset:22784
    ds_read_b64_tr_b16 v[50:51], v132 offset:23360
    ds_read_b128 v[52:55], v108 offset:22784
    v_mfma_f32_32x32x16_bf16 v[16:31], v[60:63], v[56:59], v[16:31]
    v_mfma_f32_32x32x16_bf16 v[148:163], v[56:59], v[64:67], v[148:163]
    ds_read_b128 v[56:59], v129 offset:57344
    ds_read_b64_tr_b16 v[60:61], v132 offset:25088
    ds_read_b64_tr_b16 v[62:63], v132 offset:25664
    ds_read_b128 v[64:67], v109 offset:22784
    s_waitcnt lgkmcnt(8)
    v_mfma_f32_32x32x16_bf16 v[16:31], v[36:39], v[32:35], v[16:31]
    v_mfma_f32_32x32x16_bf16 v[148:163], v[32:35], v[40:43], v[148:163]
    ds_read_b128 v[32:35], v130 offset:57344
    ds_read_b64_tr_b16 v[36:37], v132 offset:27392
    ds_read_b64_tr_b16 v[38:39], v132 offset:27968
    ds_read_b128 v[40:43], v110 offset:22784
jret_131:
    s_waitcnt lgkmcnt(8)
    v_mfma_f32_32x32x16_bf16 v[16:31], v[48:51], v[44:47], v[16:31]
    v_mfma_f32_32x32x16_bf16 v[148:163], v[44:47], v[52:55], v[148:163]
    ds_read_b32 v1, v135 offset:36
    ds_read_b128 v[44:47], v131 offset:57344
    ds_read_b64_tr_b16 v[48:49], v132 offset:29696
    ds_read_b64_tr_b16 v[50:51], v132 offset:30272
    ds_read_b128 v[52:55], v111 offset:22784
    s_waitcnt lgkmcnt(4)
    v_cmp_gt_u32 vcc, 4, v1
    v_mfma_f32_32x32x16_bf16 v[16:31], v[60:63], v[56:59], v[16:31]
    v_mfma_f32_32x32x16_bf16 v[148:163], v[56:59], v[64:67], v[148:163]
    s_cbranch_vccnz jslow_134
    v_add_u32 v128, 65536, v128
    ds_read_b128 v[56:59], v128 offset:0
    ds_read_b64_tr_b16 v[60:61], v132 offset:34176
    ds_read_b64_tr_b16 v[62:63], v132 offset:34752
    ds_read_b128 v[64:67], v108 offset:34176
    v_mfma_f32_32x32x16_bf16 v[16:31], v[36:39], v[32:35], v[16:31]
    v_mfma_f32_32x32x16_bf16 v[148:163], v[32:35], v[40:43], v[148:163]
    v_add_u32 v129, 65536, v129
    ds_read_b128 v[32:35], v129 offset:0
    ds_read_b64_tr_b16 v[36:37], v132 offset:36480
    ds_read_b64_tr_b16 v[38:39], v132 offset:37056
    ds_read_b128 v[40:43], v109 offset:34176
    s_waitcnt lgkmcnt(8)
    v_mfma_f32_32x32x16_bf16 v[16:31], v[48:51], v[44:47], v[16:31]
    v_mfma_f32_32x32x16_bf16 v[148:163], v[44:47], v[52:55], v[148:163]
    v_add_u32 v130, 65536, v130
    ds_read_b128 v[44:47], v130 offset:0
    ds_read_b64_tr_b16 v[48:49], v132 offset:38784
    ds_read_b64_tr_b16 v[50:51], v132 offset:39360
    ds_read_b128 v[52:55], v110 offset:34176
jret_135:
    s_waitcnt lgkmcnt(8)
    v_mfma_f32_32x32x16_bf16 v[16:31], v[60:63], v[56:59], v[16:31]
    v_mfma_f32_32x32x16_bf16 v[148:163], v[56:59], v[64:67], v[148:163]
    v_add_u32 v131, 65536, v131
    ds_read_b128 v[56:59], v131 offset:0
    ds_read_b64_tr_b16 v[60:61], v132 offset:41088
    ds_read_b64_tr_b16 v[62:63], v132 offset:41664
    ds_read_b128 v[64:67], v111 offset:34176
    s_waitcnt lgkmcnt(8)
    v_mfma_f32_32x32x16_bf16 v[16:31], v[36:39], v[32:35], v[16:31]
    ds_read_b32 v1, v9
    s_waitcnt lgkmcnt(5)
    v_mfma_f32_32x32x16_bf16 v[16:31], v[48:51], v[44:47], v[16:31]
    s_waitcnt lgkmcnt(1)
    v_mfma_f32_32x32x16_bf16 v[16:31], v[60:63], v[56:59], v[16:31]
    s_waitcnt lgkmcnt(0)
    v_cmp_gt_u32 vcc, 4, v1
    s_nop 0
    s_cbranch_vccz jep_138
    s_mov_b32 s15, 0
lw_139:
    ds_read_b32 v1, v9 offset:0
    s_waitcnt lgkmcnt(0)
    v_cmp_gt_u32 vcc, 4, v1
    s_nop 0
    s_cbranch_vccz lwd_140
    s_sleep 0
    s_add_u32 s15, s15, 1
    s_cmp_lt_u32 s15, 0x100000
    s_cbranch_scc1 lw_139
lwd_140:
jep_138:
    v_mfma_f32_32x32x16_bf16 v[148:163], v[32:35], v[40:43], v[148:163]
    v_mfma_f32_32x32x16_bf16 v[148:163], v[44:47], v[52:55], v[148:163]
    v_mfma_f32_32x32x16_bf16 v[148:163], v[56:59], v[64:67], v[148:163]
    s_nop 4
    v_cvt_pk_bf16_f32 v16, v16, v17
    v_cvt_pk_bf16_f32 v17, v18, v19
    ds_write2_b32 v144, v16, v17 offset0:0 offset1:1
    v_cvt_pk_bf16_f32 v20, v20, v21
    v_cvt_pk_bf16_f32 v21, v22, v23
    ds_write2_b32 v144, v20, v21 offset0:4 offset1:5
    v_cvt_pk_bf16_f32 v24, v24, v25
    v_cvt_pk_bf16_f32 v25, v26, v27
    ds_write2_b32 v144, v24, v25 offset0:8 offset1:9
    v_cvt_pk_bf16_f32 v28, v28, v29
    v_cvt_pk_bf16_f32 v29, v30, v31
    ds_write2_b32 v144, v28, v29 offset0:12 offset1:13
    s_waitcnt lgkmcnt(0)
    s_barrier
    ds_write_b128 v123, v[148:151] offset:0
    ds_write_b128 v123, v[152:155] offset:16
    ds_write_b128 v123, v[156:159] offset:32
    ds_write_b128 v123, v[160:163] offset:48
    ds_add_u32 v136, v6
    s_branch L_post_b5
jslow_106:
    s_waitcnt lgkmcnt(0)
    ds_add_u32 v7, v6 offset:128
    v_mfma_f32_32x32x16_bf16 v[16:31], v[60:63], v[56:59], v[16:31]
    v_mfma_f32_32x32x16_bf16 v[148:163], v[56:59], v[64:67], v[148:163]
    v_mfma_f32_32x32x16_bf16 v[16:31], v[36:39], v[32:35], v[16:31]
    v_mfma_f32_32x32x16_bf16 v[148:163], v[32:35], v[40:43], v[148:163]
    s_mov_b32 s15, 0
js_108:
    ds_read_b32 v1, v135 offset:8
    ds_read_b128 v[44:47], v128 offset:8192
    ds_read_b64_tr_b16 v[48:49], v132 offset:22784
    ds_read_b64_tr_b16 v[50:51], v132 offset:23360
    ds_read_b128 v[52:55], v108 offset:22784
    s_waitcnt lgkmcnt(4)
    v_cmp_gt_u32 vcc, 4, v1
    s_nop 0
    s_cbranch_vccz jsd_109
    s_add_u32 s15, s15, 1
    s_cmp_lt_u32 s15, 0x100000
    s_cbranch_scc1 js_108
jsd_109:
    ds_read_b128 v[56:59], v129 offset:8192
    ds_read_b64_tr_b16 v[60:61], v132 offset:25088
    ds_read_b64_tr_b16 v[62:63], v132 offset:25664
    ds_read_b128 v[64:67], v109 offset:22784
    ds_read_b128 v[32:35], v130 offset:8192
    ds_read_b64_tr_b16 v[36:37], v132 offset:27392
    ds_read_b64_tr_b16 v[38:39], v132 offset:27968
    ds_read_b128 v[40:43], v110 offset:22784
    s_branch jret_107
jslow_110:
    s_waitcnt lgkmcnt(0)
    ds_add_u32 v7, v6 offset:128
    v_mfma_f32_32x32x16_bf16 v[16:31], v[36:39], v[32:35], v[16:31]
    v_mfma_f32_32x32x16_bf16 v[148:163], v[32:35], v[40:43], v[148:163]
    v_mfma_f32_32x32x16_bf16 v[16:31], v[48:51], v[44:47], v[16:31]
    v_mfma_f32_32x32x16_bf16 v[148:163], v[44:47], v[52:55], v[148:163]
    s_mov_b32 s15, 0
js_112:
    ds_read_b32 v1, v135 offset:12
    ds_read_b128 v[56:59], v128 offset:16384
    ds_read_b64_tr_b16 v[60:61], v132 offset:34176
    ds_read_b64_tr_b16 v[62:63], v132 offset:34752
    ds_read_b128 v[64:67], v108 offset:34176
    s_waitcnt lgkmcnt(4)
    v_cmp_gt_u32 vcc, 4, v1
    s_nop 0
    s_cbranch_vccz jsd_113
    s_add_u32 s15, s15, 1
    s_cmp_lt_u32 s15, 0x100000
    s_cbranch_scc1 js_112
jsd_113:
    ds_read_b128 v[32:35], v129 offset:16384
    ds_read_b64_tr_b16 v[36:37], v132 offset:36480
    ds_read_b64_tr_b16 v[38:39], v132 offset:37056
    ds_read_b128 v[40:43], v109 offset:34176
    ds_read_b128 v[44:47], v130 offset:16384
    ds_read_b64_tr_b16 v[48:49], v132 offset:38784
    ds_read_b64_tr_b16 v[50:51], v132 offset:39360
    ds_read_b128 v[52:55], v110 offset:34176
    s_branch jret_111
jslow_114:
    s_waitcnt lgkmcnt(0)
    ds_add_u32 v7, v6 offset:128
    v_mfma_f32_32x32x16_bf16 v[16:31], v[48:51], v[44:47], v[16:31]
    v_mfma_f32_32x32x16_bf16 v[148:163], v[44:47], v[52:55], v[148:163]
    v_mfma_f32_32x32x16_bf16 v[16:31], v[60:63], v[56:59], v[16:31]
    v_mfma_f32_32x32x16_bf16 v[148:163], v[56:59], v[64:67], v[148:163]
    s_mov_b32 s15, 0
js_116:
    ds_read_b32 v1, v135 offset:16
    ds_read_b128 v[32:35], v128 offset:24576
    ds_read_b64_tr_b16 v[36:37], v132 offset:45568
    ds_read_b64_tr_b16 v[38:39], v132 offset:46144
    ds_read_b128 v[40:43], v108 offset:45568
    s_waitcnt lgkmcnt(4)
    v_cmp_gt_u32 vcc, 4, v1
    s_nop 0
    s_cbranch_vccz jsd_117
    s_add_u32 s15, s15, 1
    s_cmp_lt_u32 s15, 0x100000
    s_cbranch_scc1 js_116
jsd_117:
    ds_read_b128 v[44:47], v129 offset:24576
    ds_read_b64_tr_b16 v[48:49], v132 offset:47872
    ds_read_b64_tr_b16 v[50:51], v132 offset:48448
    ds_read_b128 v[52:55], v109 offset:45568
    ds_read_b128 v[56:59], v130 offset:24576
    ds_read_b64_tr_b16 v[60:61], v132 offset:50176
    ds_read_b64_tr_b16 v[62:63], v132 offset:50752
    ds_read_b128 v[64:67], v110 offset:45568
    s_branch jret_115
jslow_118:
    s_waitcnt lgkmcnt(0)
    v_mfma_f32_32x32x16_bf16 v[16:31], v[60:63], v[56:59], v[16:31]
    v_mfma_f32_32x32x16_bf16 v[148:163], v[56:59], v[64:67], v[148:163]
    v_mfma_f32_32x32x16_bf16 v[16:31], v[36:39], v[32:35], v[16:31]
    v_mfma_f32_32x32x16_bf16 v[148:163], v[32:35], v[40:43], v[148:163]
    s_mov_b32 s15, 0
js_120:
    ds_read_b32 v1, v135 offset:20
    ds_read_b128 v[44:47], v128 offset:32768
    ds_read_b64_tr_b16 v[48:49], v132 offset:56960
    ds_read_b64_tr_b16 v[50:51], v132 offset:57536
    ds_read_b128 v[52:55], v108 offset:56960
    s_waitcnt lgkmcnt(4)
    v_cmp_gt_u32 vcc, 4, v1
    s_nop 0
    s_cbranch_vccz jsd_121
    s_add_u32 s15, s15, 1
    s_cmp_lt_u32 s15, 0x100000
    s_cbranch_scc1 js_120
jsd_121:
    ds_read_b128 v[56:59], v129 offset:32768
    ds_read_b64_tr_b16 v[60:61], v132 offset:59264
    ds_read_b64_tr_b16 v[62:63], v132 offset:59840
    ds_read_b128 v[64:67], v109 offset:56960
    ds_read_b128 v[32:35], v130 offset:32768
    ds_read_b64_tr_b16 v[36:37], v132 offset:61568
    ds_read_b64_tr_b16 v[38:39], v132 offset:62144
    ds_read_b128 v[40:43], v110 offset:56960
    s_branch jret_119
jslow_122:
    s_waitcnt lgkmcnt(0)
    ds_add_u32 v7, v6 offset:128
    v_mfma_f32_32x32x16_bf16 v[16:31], v[36:39], v[32:35], v[16:31]
    v_mfma_f32_32x32x16_bf16 v[148:163], v[32:35], v[40:43], v[148:163]
    v_mfma_f32_32x32x16_bf16 v[16:31], v[48:51], v[44:47], v[16:31]
    v_mfma_f32_32x32x16_bf16 v[148:163], v[44:47], v[52:55], v[148:163]
    s_mov_b32 s15, 0
js_124:
    ds_read_b32 v1, v135 offset:24
    ds_read_b128 v[56:59], v128 offset:40960
    ds_read_b64_tr_b16 v[60:61], v132 offset:0
    ds_read_b64_tr_b16 v[62:63], v132 offset:576
    ds_read_b128 v[64:67], v108 offset:0
    s_waitcnt lgkmcnt(4)
    v_cmp_gt_u32 vcc, 4, v1
    s_nop 0
    s_cbranch_vccz jsd_125
    s_add_u32 s15, s15, 1
    s_cmp_lt_u32 s15, 0x100000
    s_cbranch_scc1 js_124
jsd_125:
    ds_read_b128 v[32:35], v129 offset:40960
    ds_read_b64_tr_b16 v[36:37], v132 offset:2304
    ds_read_b64_tr_b16 v[38:39], v132 offset:2880
    ds_read_b128 v[40:43], v109 offset:0
    ds_read_b128 v[44:47], v130 offset:40960
    ds_read_b64_tr_b16 v[48:49], v132 offset:4608
    ds_read_b64_tr_b16 v[50:51], v132 offset:5184
    ds_read_b128 v[52:55], v110 offset:0
    s_branch jret_123
jslow_126:
    s_waitcnt lgkmcnt(0)
    v_mfma_f32_32x32x16_bf16 v[16:31], v[48:51], v[44:47], v[16:31]
    v_mfma_f32_32x32x16_bf16 v[148:163], v[44:47], v[52:55], v[148:163]
    v_mfma_f32_32x32x16_bf16 v[16:31], v[60:63], v[56:59], v[16:31]
    v_mfma_f32_32x32x16_bf16 v[148:163], v[56:59], v[64:67], v[148:163]
    s_mov_b32 s15, 0
js_128:
    ds_read_b32 v1, v135 offset:28
    ds_read_b128 v[32:35], v128 offset:49152
    ds_read_b64_tr_b16 v[36:37], v132 offset:11392
    ds_read_b64_tr_b16 v[38:39], v132 offset:11968
    ds_read_b128 v[40:43], v108 offset:11392
    s_waitcnt lgkmcnt(4)
    v_cmp_gt_u32 vcc, 4, v1
    s_nop 0
    s_cbranch_vccz jsd_129
    s_add_u32 s15, s15, 1
    s_cmp_lt_u32 s15, 0x100000
    s_cbranch_scc1 js_128
jsd_129:
    ds_read_b128 v[44:47], v129 offset:49152
    ds_read_b64_tr_b16 v[48:49], v132 offset:13696
    ds_read_b64_tr_b16 v[50:51], v132 offset:14272
    ds_read_b128 v[52:55], v109 offset:11392
    ds_read_b128 v[56:59], v130 offset:49152
    ds_read_b64_tr_b16 v[60:61], v132 offset:16000
    ds_read_b64_tr_b16 v[62:63], v132 offset:16576
    ds_read_b128 v[64:67], v110 offset:11392
    s_branch jret_127
jslow_130:
    s_waitcnt lgkmcnt(0)
    v_mfma_f32_32x32x16_bf16 v[16:31], v[60:63], v[56:59], v[16:31]
    v_mfma_f32_32x32x16_bf16 v[148:163], v[56:59], v[64:67], v[148:163]
    v_mfma_f32_32x32x16_bf16 v[16:31], v[36:39], v[32:35], v[16:31]
    v_mfma_f32_32x32x16_bf16 v[148:163], v[32:35], v[40:43], v[148:163]
    s_mov_b32 s15, 0
js_132:
    ds_read_b32 v1, v135 offset:32
    ds_read_b128 v[44:47], v128 offset:57344
    ds_read_b64_tr_b16 v[48:49], v132 offset:22784
    ds_read_b64_tr_b16 v[50:51], v132 offset:23360
    ds_read_b128 v[52:55], v108 offset:22784
    s_waitcnt lgkmcnt(4)
    v_cmp_gt_u32 vcc, 4, v1
    s_nop 0
    s_cbranch_vccz jsd_133
    s_add_u32 s15, s15, 1
    s_cmp_lt_u32 s15, 0x100000
    s_cbranch_scc1 js_132
jsd_133:
    ds_read_b128 v[56:59], v129 offset:57344
    ds_read_b64_tr_b16 v[60:61], v132 offset:25088
    ds_read_b64_tr_b16 v[62:63], v132 offset:25664
    ds_read_b128 v[64:67], v109 offset:22784
    ds_read_b128 v[32:35], v130 offset:57344
    ds_read_b64_tr_b16 v[36:37], v132 offset:27392
    ds_read_b64_tr_b16 v[38:39], v132 offset:27968
    ds_read_b128 v[40:43], v110 offset:22784
    s_branch jret_131
jslow_134:
    s_waitcnt lgkmcnt(0)
    v_mfma_f32_32x32x16_bf16 v[16:31], v[36:39], v[32:35], v[16:31]
    v_mfma_f32_32x32x16_bf16 v[148:163], v[32:35], v[40:43], v[148:163]
    v_mfma_f32_32x32x16_bf16 v[16:31], v[48:51], v[44:47], v[16:31]
    v_mfma_f32_32x32x16_bf16 v[148:163], v[44:47], v[52:55], v[148:163]
    v_add_u32 v128, 65536, v128
    s_mov_b32 s15, 0
js_136:
    ds_read_b32 v1, v135 offset:36
    ds_read_b128 v[56:59], v128 offset:0
    ds_read_b64_tr_b16 v[60:61], v132 offset:34176
    ds_read_b64_tr_b16 v[62:63], v132 offset:34752
    ds_read_b128 v[64:67], v108 offset:34176
    s_waitcnt lgkmcnt(4)
    v_cmp_gt_u32 vcc, 4, v1
    s_nop 0
    s_cbranch_vccz jsd_137
    s_add_u32 s15, s15, 1
    s_cmp_lt_u32 s15, 0x100000
    s_cbranch_scc1 js_136
jsd_137:
    v_add_u32 v129, 65536, v129
    ds_read_b128 v[32:35], v129 offset:0
    ds_read_b64_tr_b16 v[36:37], v132 offset:36480
    ds_read_b64_tr_b16 v[38:39], v132 offset:37056
    ds_read_b128 v[40:43], v109 offset:34176
    v_add_u32 v130, 65536, v130
    ds_read_b128 v[44:47], v130 offset:0
    ds_read_b64_tr_b16 v[48:49], v132 offset:38784
    ds_read_b64_tr_b16 v[50:51], v132 offset:39360
    ds_read_b128 v[52:55], v110 offset:34176
    s_branch jret_135
L_stream:
    s_setprio 3
    v_lshrrev_b32 v1, 3, v0
    v_and_b32 v13, 7, v0
    v_lshrrev_b32 v14, 4, v0
    v_xor_b32 v13, v13, v14
    v_lshlrev_b32 v13, 4, v13
    v_mul_u32_u24 v18, 1152, v1
    v_add_u32 v18, v18, v13
    v_xor_b32 v19, 64, v18
    v_lshrrev_b32 v16, 2, v1
    v_and_b32 v14, 3, v1
    v_lshl_add_u32 v16, v16, 5, v14
    v_mul_u32_u24 v16, 1152, v16
    v_add_u32 v16, v16, v13
    v_xor_b32 v17, 64, v16
    v_mul_u32_u24 v1, 57, v0
    v_lshrrev_b32 v1, 9, v1
    v_mul_u32_u24 v13, 9, v1
    v_sub_u32 v13, v0, v13
    v_and_b32 v14, 1, v1
    v_add3_u32 v13, v13, v14, -1
    v_and_b32 v14, 2, v1
    v_sub_u32 v15, v13, v14
    v_add3_u32 v14, v13, v14, -2
    v_and_b32 v15, 7, v15
    v_and_b32 v14, 7, v14
    v_cmp_gt_u32 vcc, 8, v13
    s_nop 1
    v_cndmask_b32 v15, 8, v15, vcc
    v_cndmask_b32 v14, 8, v14, vcc
    v_mul_u32_u24 v1, 1152, v1
    v_lshl_add_u32 v20, v15, 4, v1
    v_lshl_add_u32 v21, v14, 4, v1
    s_sub_u32 s8, s5, 5
    s_lshl_b32 s8, s8, 2
    v_add_u32 v23, s8, v135
    v_lshl_add_u32 v22, v0, 18, v23
    v_mov_b32 v24, 4
    v_mov_b32 v25, 162640
    s_waitcnt lgkmcnt(0)
    s_mov_b32 s52, s50
    s_mov_b32 s53, s51
    s_mov_b32 s54, 8388608
    s_mov_b32 s55, 0x20000
    s_mov_b32 s60, s16
    s_mov_b32 s61, s17
    s_mov_b32 s62, 2359296
    s_mov_b32 s63, 0x20000
    s_mov_b32 s72, s36
    s_mov_b32 s73, s37
    s_mov_b32 s74, 663552
    s_mov_b32 s75, 0x20000
    s_mov_b32 s76, s22
    s_mov_b32 s77, s23
    s_mov_b32 s78, 663552
    s_mov_b32 s79, 0x20000
    s_mov_b32 s92, s24
    s_mov_b32 s93, s25
    s_mov_b32 s94, 663552
    s_mov_b32 s95, 0x20000
    s_mov_b32 s96, s44
    s_mov_b32 s97, s45
    s_mov_b32 s98, 1152
    s_mov_b32 s99, 0x20000
    s_sub_u32 s21, s5, 5
    s_mul_i32 s9, s3, 73728
    s_lshl_b32 s10, s21, 13
    s_add_u32 s8, s4, 1
    s_and_b32 s8, s8, 3
    s_lshl_b32 s28, s8, 11
    s_add_u32 s28, s28, s10
    s_mul_i32 s8, s8, 9216
    s_add_u32 s18, s8, s9
    s_add_u32 s8, s4, 2
    s_and_b32 s8, s8, 3
    s_lshl_b32 s29, s8, 11
    s_add_u32 s29, s29, s10
    s_mul_i32 s8, s8, 9216
    s_add_u32 s19, s8, s9
    s_add_u32 s8, s4, 3
    s_and_b32 s8, s8, 3
    s_lshl_b32 s30, s8, 11
    s_add_u32 s30, s30, s10
    s_mul_i32 s8, s8, 9216
    s_add_u32 s26, s8, s9
    s_mul_i32 s31, s4, 82944
    s_add_u32 s31, s31, 73728
    s_mul_i32 s27, s4, 144
    s_add_u32 s8, s80, 0
    s_sub_u32 s9, s8, 3
    s_cmp_ge_u32 s8, 3
    s_cselect_b32 s8, s9, s8
    s_mul_i32 s8, s8, 3
    s_add_u32 s8, s8, s21
    s_lshl_b32 s20, s8, 7
    s_mul_i32 s12, s8, 73728
    s_add_u32 s12, s12, s27
    s_add_u32 s13, s21, 1
    s_cmp_eq_u32 s13, 6
    s_cselect_b32 s13, 0, s13
    s_mul_i32 s13, s13, 11392
    s_add_u32 s11, s31, s20
    s_barrier
    s_cmp_lt_u32 s21, 2
    s_cbranch_scc1 notok_141
    v_add_u32 v13, -8, v23
    s_mov_b32 s15, 0
lw_142:
    ds_read_b32 v1, v13 offset:0
    s_waitcnt lgkmcnt(0)
    v_cmp_gt_u32 vcc, 4, v1
    s_nop 0
    s_cbranch_vccz lwd_143
    s_sleep 1
    s_add_u32 s15, s15, 1
    s_cmp_lt_u32 s15, 0x100000
    s_cbranch_scc1 lw_142
lwd_143:
notok_141:
    s_mov_b32 s15, 0
lw_144:
    ds_read_b32 v1, v23 offset:40
    s_waitcnt lgkmcnt(0)
    v_cmp_gt_u32 vcc, 4, v1
    s_nop 0
    s_cbranch_vccz lwd_145
    s_sleep 0
    s_add_u32 s15, s15, 1
    s_cmp_lt_u32 s15, 0x100000
    s_cbranch_scc1 lw_144
lwd_145:
    s_mov_b32 exec_hi, 0x3fffff
    s_add_u32 m0, s13, 94208
    s_add_u32 s14, s12, 0
    buffer_load_dwordx4 v20, s[72:75], s14 offen lds
    s_add_u32 m0, s13, 95072
    s_add_u32 s14, s12, 6912
    buffer_load_dwordx4 v21, s[72:75], s14 offen lds
    s_add_u32 m0, s13, 95936
    s_add_u32 s14, s12, 13824
    buffer_load_dwordx4 v20, s[72:75], s14 offen lds
    s_add_u32 m0, s13, 96800
    s_add_u32 s14, s12, 20736
    buffer_load_dwordx4 v21, s[72:75], s14 offen lds
    s_add_u32 m0, s13, 97664
    s_add_u32 s14, s12, 27648
    buffer_load_dwordx4 v20, s[72:75], s14 offen lds
    s_add_u32 m0, s13, 98528
    s_add_u32 s14, s12, 34560
    buffer_load_dwordx4 v21, s[72:75], s14 offen lds
    s_add_u32 m0, s13, 99392
    s_add_u32 s14, s12, 41472
    buffer_load_dwordx4 v20, s[72:75], s14 offen lds
    ds_write_b32 v22, v24 offset:44
    s_add_u32 m0, s13, 100256
    s_add_u32 s14, s12, 48384
    buffer_load_dwordx4 v21, s[72:75], s14 offen lds
    s_add_u32 m0, s13, 101120
    s_add_u32 s14, s12, 55296
    buffer_load_dwordx4 v20, s[72:75], s14 offen lds
    s_add_u32 m0, s13, 101984
    s_add_u32 s14, s12, 62208
    buffer_load_dwordx4 v21, s[72:75], s14 offen lds
    s_mov_b32 exec_hi, 15
    s_add_u32 m0, s13, 102848
    s_add_u32 s14, s12, 69120
    buffer_load_dwordx4 v20, s[72:75], s14 offen lds
    s_mov_b64 exec, 0xff
    s_add_u32 m0, s13, 105472
    s_add_u32 s14, s20, 0
    buffer_load_dwordx4 v10, s[96:99], s14 offen lds
    s_mov_b64 exec, -1
    s_add_u32 m0, s13, 103424
    s_add_u32 s14, s11, 0
    buffer_load_dwordx4 v18, s[76:79], s14 offen lds
    s_add_u32 m0, s13, 104448
    s_add_u32 s14, s11, 0
    buffer_load_dwordx4 v19, s[92:95], s14 offen lds
    s_add_u32 s11, s20, 4608
    s_add_u32 m0, s28, 0
    s_add_u32 s14, s18, s20
    buffer_load_dwordx4 v16, s[60:63], s14 offen lds
    s_add_u32 m0, s28, 1024
    s_add_u32 s14, s18, s11
    buffer_load_dwordx4 v17, s[60:63], s14 offen lds
    s_add_u32 m0, s29, 0
    s_add_u32 s14, s19, s20
    buffer_load_dwordx4 v16, s[60:63], s14 offen lds
    s_add_u32 m0, s29, 1024
    s_add_u32 s14, s19, s11
    buffer_load_dwordx4 v17, s[60:63], s14 offen lds
    s_add_u32 m0, s30, 0
    s_add_u32 s14, s26, s20
    buffer_load_dwordx4 v16, s[60:63], s14 offen lds
    s_add_u32 m0, s30, 1024
    s_add_u32 s14, s26, s11
    buffer_load_dwordx4 v17, s[60:63], s14 offen lds
    v_and_b32 v1, 31, v0
    v_lshrrev_b32 v13, 5, v0
    v_bfe_u32 v14, v0, 1, 3
    v_xor_b32 v13, v13, v14
    v_lshlrev_b32 v13, 4, v13
    v_lshl_add_u32 v128, v1, 7, v13
    v_xor_b32 v129, 32, v128
    v_xor_b32 v130, 64, v128
    v_xor_b32 v131, 96, v128
    v_add_u32 v2, 73728, v10
    v_and_b32 v117, 31, v0
    v_add_u32 v1, 82944, v10
    v_mov_b32 v13, 75040
    v_cmp_gt_u32 vcc, 32, v0
    s_nop 1
    v_cndmask_b32 v3, v13, v1, vcc
    v_mad_u32_u24 v1, v116, 19, v117
    v_lshlrev_b32 v1, 4, v1
    v_add_u32 v1, 74752, v1
    v_mov_b32 v118, 262144
    v_cmp_gt_u32 vcc, 19, v117
    s_nop 1
    v_cndmask_b32 v4, v118, v1, vcc
    v_mov_b32 v5, 0xdddddddd
    s_lshl_b32 s8, s5, 2
    s_add_u32 s8, s8, 162560
    v_mov_b32 v1, s8
    v_cmp_eq_u32 vcc, 0, v0
    s_nop 1
    v_cndmask_b32 v7, v118, v1, vcc
    v_and_b32 v1, 15, v0
    v_min_u32 v1, 12, v1
    v_lshlrev_b32 v1, 2, v1
    v_add_u32 v8, 162560, v1
    v_lshlrev_b32 v11, 2, v0
    v_and_b32 v9, 12, v11
    v_add_u32 v9, 162688, v9
    s_lshl_b32 s8, s82, 5
    v_add_u32 v119, s8, v117
    v_mul_u32_u24 v120, 148, v119
    s_mul_i32 s8, s83, 36
    s_add_u32 s8, s8, 148224
    v_add_u32 v120, s8, v120
    v_lshl_add_u32 v121, v116, 18, v120
    v_lshl_add_u32 v120, v116, 4, v120
    v_mov_b32 v122, 162656
    v_add_u32 v72, 139776, v10
    v_add_u32 v1, 2048, v72
    v_cmp_gt_u32 vcc, 32, v0
    s_nop 1
    v_cndmask_b32 v73, v3, v1, vcc
    s_mov_b32 s56, s52
    s_mov_b32 s57, s53
    s_mov_b32 s58, s54
    s_mov_b32 s59, 0x20000
    s_mul_i32 s8, s5, 1280
    s_add_u32 s86, s8, 73728
    s_add_u32 s87, s8, 86016
    s_mov_b32 s84, 0
    v_lshlrev_b32 v141, 4, v119
    v_lshl_add_u32 v140, v116, 10, v141
    v_lshl_add_u32 v141, v116, 30, v141
    v_lshlrev_b32 v119, 3, v119
    v_add_u32 v119, 163072, v119
    s_mul_i32 s8, s3, 73728
    s_add_u32 s8, s8, 5242880
    s_lshl_b32 s10, s4, 2
    s_add_u32 s10, s10, s83
    s_lshl_b32 s9, s10, 11
    s_add_u32 s88, s9, s8
    s_lshl_b32 s14, s4, 10
    s_add_u32 s8, s8, s14
    s_lshl_b32 s14, s83, 2
    s_add_u32 s8, s8, s14
    s_add_u32 s89, s8, 65536
    v_mov_b32 v80, 0
    v_mov_b32 v81, 0
    v_mov_b32 v82, 0
    v_mov_b32 v83, 0
    v_mov_b32 v84, 0
    v_mov_b32 v85, 0
    v_mov_b32 v86, 0
    v_mov_b32 v87, 0
    v_mov_b32 v88, 0
    v_mov_b32 v89, 0
    v_mov_b32 v90, 0
    v_mov_b32 v91, 0
    v_mov_b32 v92, 0
    v_mov_b32 v93, 0
    v_mov_b32 v94, 0
    v_mov_b32 v95, 0
    s_add_u32 s8, s80, 1
    s_sub_u32 s9, s8, 3
    s_cmp_ge_u32 s8, 3
    s_cselect_b32 s8, s9, s8
    s_mul_i32 s8, s8, 3
    s_add_u32 s8, s8, s21
    s_lshl_b32 s20, s8, 7
    s_mul_i32 s12, s8, 73728
    s_add_u32 s12, s12, s27
    s_add_u32 s13, s21, 4
    s_cmp_eq_u32 s13, 6
    s_cselect_b32 s13, 0, s13
    s_mul_i32 s13, s13, 11392
    s_add_u32 s11, s31, s20
    s_mov_b32 s15, 0
lw_146:
    ds_read_b32 v1, v25 offset:0
    s_waitcnt lgkmcnt(0)
    v_cmp_gt_u32 vcc, 3, v1
    s_nop 0
    s_cbranch_vccz lwd_147
    s_sleep 0
    s_add_u32 s15, s15, 1
    s_cmp_lt_u32 s15, 0x100000
    s_cbranch_scc1 lw_146
lwd_147:
    s_waitcnt vmcnt(0)
    ds_write_b32 v22, v24 offset:4
    s_mov_b32 s15, 0
lw_148:
    ds_read_b32 v1, v23 offset:52
    s_waitcnt lgkmcnt(0)
    v_cmp_gt_u32 vcc, 4, v1
    s_nop 0
    s_cbranch_vccz lwd_149
    s_sleep 0
    s_add_u32 s15, s15, 1
    s_cmp_lt_u32 s15, 0x100000
    s_cbranch_scc1 lw_148
lwd_149:
    s_mov_b32 exec_hi, 0x3fffff
    s_add_u32 m0, s13, 94208
    s_add_u32 s14, s12, 0
    buffer_load_dwordx4 v20, s[72:75], s14 offen lds
    s_add_u32 m0, s13, 95072
    s_add_u32 s14, s12, 6912
    buffer_load_dwordx4 v21, s[72:75], s14 offen lds
    s_add_u32 m0, s13, 95936
    s_add_u32 s14, s12, 13824
    buffer_load_dwordx4 v20, s[72:75], s14 offen lds
    s_add_u32 m0, s13, 96800
    s_add_u32 s14, s12, 20736
    buffer_load_dwordx4 v21, s[72:75], s14 offen lds
    s_add_u32 m0, s13, 97664
    s_add_u32 s14, s12, 27648
    buffer_load_dwordx4 v20, s[72:75], s14 offen lds
    s_add_u32 m0, s13, 98528
    s_add_u32 s14, s12, 34560
    buffer_load_dwordx4 v21, s[72:75], s14 offen lds
    s_add_u32 m0, s13, 99392
    s_add_u32 s14, s12, 41472
    buffer_load_dwordx4 v20, s[72:75], s14 offen lds
    ds_write_b32 v22, v24 offset:56
    s_add_u32 m0, s13, 100256
    s_add_u32 s14, s12, 48384
    buffer_load_dwordx4 v21, s[72:75], s14 offen lds
    s_add_u32 m0, s13, 101120
    s_add_u32 s14, s12, 55296
    buffer_load_dwordx4 v20, s[72:75], s14 offen lds
    s_add_u32 m0, s13, 101984
    s_add_u32 s14, s12, 62208
    buffer_load_dwordx4 v21, s[72:75], s14 offen lds
    s_mov_b32 exec_hi, 15
    s_add_u32 m0, s13, 102848
    s_add_u32 s14, s12, 69120
    buffer_load_dwordx4 v20, s[72:75], s14 offen lds
    s_mov_b64 exec, 0xff
    s_add_u32 m0, s13, 105472
    s_add_u32 s14, s20, 0
    buffer_load_dwordx4 v10, s[96:99], s14 offen lds
    s_mov_b64 exec, -1
    s_add_u32 m0, s13, 103424
    s_add_u32 s14, s11, 0
    buffer_load_dwordx4 v18, s[76:79], s14 offen lds
    s_add_u32 m0, s13, 104448
    s_add_u32 s14, s11, 0
    buffer_load_dwordx4 v19, s[92:95], s14 offen lds
    s_add_u32 s11, s20, 4608
    s_add_u32 m0, s28, 24576
    s_add_u32 s14, s18, s20
    buffer_load_dwordx4 v16, s[60:63], s14 offen lds
    s_add_u32 m0, s28, 25600
    s_add_u32 s14, s18, s11
    buffer_load_dwordx4 v17, s[60:63], s14 offen lds
    s_add_u32 m0, s29, 24576
    s_add_u32 s14, s19, s20
    buffer_load_dwordx4 v16, s[60:63], s14 offen lds
    s_add_u32 m0, s29, 25600
    s_add_u32 s14, s19, s11
    buffer_load_dwordx4 v17, s[60:63], s14 offen lds
    s_add_u32 m0, s30, 24576
    s_add_u32 s14, s26, s20
    buffer_load_dwordx4 v16, s[60:63], s14 offen lds
    s_add_u32 m0, s30, 25600
    s_add_u32 s14, s26, s11
    buffer_load_dwordx4 v17, s[60:63], s14 offen lds
    s_mov_b32 s64, s46
    s_mov_b32 s65, s47
    s_mov_b32 s66, 4718592
    s_mov_b32 s67, 0x20000
    s_mov_b32 s68, s32
    s_mov_b32 s69, s33
    s_mov_b32 s70, 1152
    s_mov_b32 s71, 0x20000
    s_lshl_b32 s8, s3, 3
    s_add_u32 s8, s8, s5
    s_mul_i32 s8, s8, 18432
    s_mul_i32 s9, s4, 288
    s_add_u32 s90, s8, s9
    s_mul_i32 s10, s4, 18
    s_mul_i32 s11, s80, 48
    s_sub_u32 s10, s10, s11
    s_add_u32 s10, s10, 144
    s_and_b32 s11, s5, 3
    s_lshl_b32 s11, s11, 11
    s_lshr_b32 s12, s5, 2
    s_lshl_b32 s12, s12, 2
    v_add_u32 v1, 0, v0
    v_mul_u32_u24 v13, 57, v1
    v_lshrrev_b32 v13, 10, v13
    v_mul_u32_u24 v14, 126, v13
    v_add_u32 v14, v14, v1
    v_lshlrev_b32 v164, 4, v14
    v_mul_u32_u24 v14, 18, v13
    v_sub_u32 v1, v1, v14
    v_lshlrev_b32 v146, 3, v1
    v_add_u32 v1, s10, v1
    v_subrev_u32 v14, 144, v1
    v_min_u32 v1, v1, v14
    v_and_b32 v14, 3, v13
    v_add_u32 v14, s12, v14
    v_and_b32 v13, 4, v13
    v_lshrrev_b32 v15, 1, v14
    v_add_u32 v15, v15, v13
    v_lshlrev_b32 v15, 1, v15
    v_xor_b32 v15, v15, v1
    v_and_b32 v15, 15, v15
    v_lshlrev_b32 v15, 3, v15
    v_lshl_add_u32 v15, v14, 7, v15
    v_lshl_add_u32 v15, v13, 8, v15
    v_lshrrev_b32 v1, 4, v1
    v_lshl_add_u32 v15, v1, 13, v15
    v_add_u32 v68, s11, v15
    v_add_u32 v1, 64, v0
    v_mul_u32_u24 v13, 57, v1
    v_lshrrev_b32 v13, 10, v13
    v_mul_u32_u24 v14, 126, v13
    v_add_u32 v14, v14, v1
    v_lshlrev_b32 v165, 4, v14
    v_mul_u32_u24 v14, 18, v13
    v_sub_u32 v1, v1, v14
    v_lshlrev_b32 v138, 3, v1
    v_add_u32 v1, s10, v1
    v_subrev_u32 v14, 144, v1
    v_min_u32 v1, v1, v14
    v_and_b32 v14, 3, v13
    v_add_u32 v14, s12, v14
    v_and_b32 v13, 4, v13
    v_lshrrev_b32 v15, 1, v14
    v_add_u32 v15, v15, v13
    v_lshlrev_b32 v15, 1, v15
    v_xor_b32 v15, v15, v1
    v_and_b32 v15, 15, v15
    v_lshlrev_b32 v15, 3, v15
    v_lshl_add_u32 v15, v14, 7, v15
    v_lshl_add_u32 v15, v13, 8, v15
    v_lshrrev_b32 v1, 4, v1
    v_lshl_add_u32 v15, v1, 13, v15
    v_add_u32 v69, s11, v15
    v_add_u32 v1, 128, v0
    v_mul_u32_u24 v13, 57, v1
    v_lshrrev_b32 v13, 10, v13
    v_mul_u32_u24 v14, 126, v13
    v_add_u32 v14, v14, v1
    v_lshlrev_b32 v166, 4, v14
    v_mul_u32_u24 v14, 18, v13
    v_sub_u32 v1, v1, v14
    v_lshlrev_b32 v142, 3, v1
    v_add_u32 v1, s10, v1
    v_subrev_u32 v14, 144, v1
    v_min_u32 v1, v1, v14
    v_and_b32 v14, 3, v13
    v_add_u32 v14, s12, v14
    v_and_b32 v13, 4, v13
    v_lshrrev_b32 v15, 1, v14
    v_add_u32 v15, v15, v13
    v_lshlrev_b32 v15, 1, v15
    v_xor_b32 v15, v15, v1
    v_and_b32 v15, 15, v15
    v_lshlrev_b32 v15, 3, v15
    v_lshl_add_u32 v15, v14, 7, v15
    v_lshl_add_u32 v15, v13, 8, v15
    v_lshrrev_b32 v1, 4, v1
    v_lshl_add_u32 v15, v1, 13, v15
    v_add_u32 v70, s11, v15
    v_mov_b32 v1, 2146435072
    s_mov_b64 vcc, 0xffff
    v_cndmask_b32 v166, v1, v166, vcc
    s_mul_i32 s9, s4, 144
    s_cmp_lg_u32 s5, 0
    s_cbranch_scc1 nodsk_150
    s_mov_b32 m0, 163584
    s_nop 0
    buffer_load_dword v11, s[68:71], s9 offen lds
nodsk_150:
    s_add_u32 s8, s80, 2
    s_sub_u32 s9, s8, 3
    s_cmp_ge_u32 s8, 3
    s_cselect_b32 s8, s9, s8
    s_mul_i32 s8, s8, 3
    s_add_u32 s8, s8, s21
    s_lshl_b32 s20, s8, 7
    s_mul_i32 s12, s8, 73728
    s_add_u32 s12, s12, s27
    s_add_u32 s13, s21, 1
    s_cmp_eq_u32 s13, 6
    s_cselect_b32 s13, 0, s13
    s_mul_i32 s13, s13, 11392
    s_add_u32 s11, s31, s20
    s_add_u32 s10, s21, 1
    s_mov_b32 s15, 0
lw_151:
    ds_read_b32 v1, v9 offset:0
    s_waitcnt lgkmcnt(0)
    v_cmp_gt_u32 vcc, s10, v1
    s_nop 0
    s_cbranch_vccz lwd_152
    s_sleep 0
    s_add_u32 s15, s15, 1
    s_cmp_lt_u32 s15, 0x100000
    s_cbranch_scc1 lw_151
lwd_152:
    s_waitcnt vmcnt(0)
    ds_write_b32 v22, v24 offset:16
    s_mov_b32 s15, 0
lw_153:
    ds_read_b32 v1, v23 offset:64
    s_waitcnt lgkmcnt(0)
    v_cmp_gt_u32 vcc, 4, v1
    s_nop 0
    s_cbranch_vccz lwd_154
    s_sleep 0
    s_add_u32 s15, s15, 1
    s_cmp_lt_u32 s15, 0x100000
    s_cbranch_scc1 lw_153
lwd_154:
    s_mov_b32 exec_hi, 0x3fffff
    s_add_u32 m0, s13, 94208
    s_add_u32 s14, s12, 0
    buffer_load_dwordx4 v20, s[72:75], s14 offen lds
    s_add_u32 m0, s13, 95072
    s_add_u32 s14, s12, 6912
    buffer_load_dwordx4 v21, s[72:75], s14 offen lds
    s_add_u32 m0, s13, 95936
    s_add_u32 s14, s12, 13824
    buffer_load_dwordx4 v20, s[72:75], s14 offen lds
    s_add_u32 m0, s13, 96800
    s_add_u32 s14, s12, 20736
    buffer_load_dwordx4 v21, s[72:75], s14 offen lds
    s_add_u32 m0, s13, 97664
    s_add_u32 s14, s12, 27648
    buffer_load_dwordx4 v20, s[72:75], s14 offen lds
    s_add_u32 m0, s13, 98528
    s_add_u32 s14, s12, 34560
    buffer_load_dwordx4 v21, s[72:75], s14 offen lds
    s_add_u32 m0, s13, 99392
    s_add_u32 s14, s12, 41472
    buffer_load_dwordx4 v20, s[72:75], s14 offen lds
    ds_write_b32 v22, v24 offset:68
    s_add_u32 m0, s13, 100256
    s_add_u32 s14, s12, 48384
    buffer_load_dwordx4 v21, s[72:75], s14 offen lds
    s_add_u32 m0, s13, 101120
    s_add_u32 s14, s12, 55296
    buffer_load_dwordx4 v20, s[72:75], s14 offen lds
    s_add_u32 m0, s13, 101984
    s_add_u32 s14, s12, 62208
    buffer_load_dwordx4 v21, s[72:75], s14 offen lds
    s_mov_b32 exec_hi, 15
    s_add_u32 m0, s13, 102848
    s_add_u32 s14, s12, 69120
    buffer_load_dwordx4 v20, s[72:75], s14 offen lds
    s_mov_b64 exec, 0xff
    s_add_u32 m0, s13, 105472
    s_add_u32 s14, s20, 0
    buffer_load_dwordx4 v10, s[96:99], s14 offen lds
    s_mov_b64 exec, -1
    s_add_u32 m0, s13, 103424
    s_add_u32 s14, s11, 0
    buffer_load_dwordx4 v18, s[76:79], s14 offen lds
    s_add_u32 m0, s13, 104448
    s_add_u32 s14, s11, 0
    buffer_load_dwordx4 v19, s[92:95], s14 offen lds
    s_add_u32 s11, s20, 4608
    s_add_u32 m0, s28, 49152
    s_add_u32 s14, s18, s20
    buffer_load_dwordx4 v16, s[60:63], s14 offen lds
    s_add_u32 m0, s28, 50176
    s_add_u32 s14, s18, s11
    buffer_load_dwordx4 v17, s[60:63], s14 offen lds
    s_add_u32 m0, s29, 49152
    s_add_u32 s14, s19, s20
    buffer_load_dwordx4 v16, s[60:63], s14 offen lds
    s_add_u32 m0, s29, 50176
    s_add_u32 s14, s19, s11
    buffer_load_dwordx4 v17, s[60:63], s14 offen lds
    s_add_u32 m0, s30, 49152
    s_add_u32 s14, s26, s20
    buffer_load_dwordx4 v16, s[60:63], s14 offen lds
    s_add_u32 m0, s30, 50176
    s_add_u32 s14, s26, s11
    buffer_load_dwordx4 v17, s[60:63], s14 offen lds
    s_waitcnt vmcnt(0)
    ds_write_b32 v22, v24 offset:28
L_kv_rest:
L_pre_done:
    s_waitcnt vmcnt(0) lgkmcnt(0)
    s_barrier
L_post_b5:
    s_setprio 3
    ds_read2_b32 v[96:97], v120 offset0:0 offset1:1
    ds_read2_b32 v[98:99], v120 offset0:2 offset1:3
    ds_read_b32 v100, v121 offset:32
    ds_read_b128 v[128:131], v122
    ds_read_b128 v[104:107], v72
    ds_read_b128 v[124:127], v73
    s_add_u32 m0, s86, 20480
    s_add_u32 s87, s87, 10240
    buffer_load_dwordx4 v10, s[56:59], s87 offen sc1 lds
    buffer_load_dword v11, s[56:59], s87 offen offset:1024 sc1 lds
    s_mov_b32 s91, 0x3ffc
    s_xor_b32 s93, s5, 4
    v_mov_b32 v123, 0
    s_waitcnt lgkmcnt(1)
    v_mfma_f32_32x32x16_bf16 v[16:31], v[104:107], v[96:99], 0
    ds_read_b64 v[132:133], v68
    ds_read_b64 v[134:135], v69
    ds_read_b64 v[136:137], v70
    ds_read_b128 v[104:107], v72 offset:1024
    v_dot2c_f32_bf16 v123, v96, v96
    v_dot2c_f32_bf16 v123, v97, v97
    v_dot2c_f32_bf16 v123, v98, v98
    v_dot2c_f32_bf16 v123, v99, v99
    v_dot2c_f32_bf16 v123, v100, v100
    v_max3_f32 v128, v128, v129, v130
    v_max_f32 v128, v128, v131
    v_mov_b32 v103, v100
    v_mul_f32 v123, v123, v128
    v_mov_b32 v129, v123
    s_mov_b32 s8, 0
    s_mov_b32 s9, -1
    v_permlane32_swap_b32 v129, v123
    v_add_f32 v123, v129, v123
    v_sqrt_f32 v123, v123
    s_nop 0
    v_cmp_nge_f32 vcc, 1109393408, v123
    v_lshrrev_b32 v123, 16, v123
    v_or_b32 v123, 0x8000, v123
    v_cndmask_b32 v101, 0, v123, s[8:9]
    v_cndmask_b32 v102, 0, v123, s[8:9]
    s_cbranch_vccnz L_fallback
L_have_max:
    s_waitcnt lgkmcnt(0)
    v_mfma_f32_32x32x8_bf16 v[16:31], v[124:125], v[100:101], v[16:31]
    ds_read_b128 v[108:111], v4
    ds_read_b128 v[112:115], v4 offset:640
    v_mfma_f32_32x32x16_bf16 v[32:47], v[104:107], v[96:99], 0
    ds_read_b128 v[104:107], v2
    s_add_u32 m0, s86, 30720
    s_add_u32 s87, s87, 10240
    buffer_load_dwordx4 v10, s[56:59], s87 offen sc1 lds
    buffer_load_dword v11, s[56:59], s87 offen offset:1024 sc1 lds
    ds_add_u32 v7, v6
    v_mfma_f32_32x32x8_bf16 v[32:47], v[124:125], v[102:103], v[32:47]
    s_mov_b32 s84, 1
    s_branch L_aentry
.p2align 6
L_aloop:
    s_waitcnt vmcnt(2) lgkmcnt(0)
    v_smfmac_f32_32x32x32_bf16 v[80:95], v[108:111], v[64:71], v5
    ds_read_b128 v[108:111], v4 offset:0
    ds_add_u32 v7, v6
    v_mfma_f32_32x32x16_bf16 v[32:47], v[104:107], v[96:99], 0
    ds_read_b128 v[104:107], v2 offset:0
    v_smfmac_f32_32x32x32_bf16 v[80:95], v[112:115], v[72:79], v5
    ds_read_b128 v[112:115], v4 offset:640
    v_mfma_f32_32x32x8_bf16 v[32:47], v[124:125], v[102:103], v[32:47]
    s_add_u32 s84, s84, 1
L_aentry:
    s_setprio 1
    v_exp_f32 v16, v16
    v_exp_f32 v17, v17
    v_exp_f32 v18, v18
    v_exp_f32 v19, v19
    s_setprio 2
    v_exp_f32 v20, v20
    v_exp_f32 v21, v21
    v_exp_f32 v22, v22
    v_exp_f32 v23, v23
    v_exp_f32 v24, v24
    v_exp_f32 v25, v25
    v_exp_f32 v26, v26
    v_exp_f32 v27, v27
    v_exp_f32 v28, v28
    v_exp_f32 v29, v29
    v_exp_f32 v30, v30
    v_exp_f32 v31, v31
    s_waitcnt lgkmcnt(0)
    v_smfmac_f32_32x32x32_bf16 v[80:95], v[108:111], v[16:23], v5
    ds_read_b128 v[108:111], v4 offset:2304
    v_mfma_f32_32x32x16_bf16 v[48:63], v[104:107], v[96:99], 0
    ds_read_b128 v[104:107], v2 offset:2304
    v_smfmac_f32_32x32x32_bf16 v[80:95], v[112:115], v[24:31], v5
    ds_read_b128 v[112:115], v4 offset:2944
    v_mfma_f32_32x32x8_bf16 v[48:63], v[126:127], v[100:101], v[48:63]
    s_setprio 1
    v_exp_f32 v32, v32
    v_exp_f32 v33, v33
    v_exp_f32 v34, v34
    v_exp_f32 v35, v35
    s_setprio 2
    v_exp_f32 v36, v36
    v_exp_f32 v37, v37
    v_exp_f32 v38, v38
    v_exp_f32 v39, v39
    v_exp_f32 v40, v40
    v_exp_f32 v41, v41
    v_exp_f32 v42, v42
    v_exp_f32 v43, v43
    v_exp_f32 v44, v44
    v_exp_f32 v45, v45
    v_exp_f32 v46, v46
    v_exp_f32 v47, v47
    s_waitcnt lgkmcnt(0)
    v_smfmac_f32_32x32x32_bf16 v[80:95], v[108:111], v[32:39], v5
    ds_read_b128 v[108:111], v4 offset:4608
    v_mfma_f32_32x32x16_bf16 v[64:79], v[104:107], v[96:99], 0
    ds_read_b128 v[104:107], v2 offset:4608
    v_smfmac_f32_32x32x32_bf16 v[80:95], v[112:115], v[40:47], v5
    ds_read_b128 v[112:115], v4 offset:5248
    v_mfma_f32_32x32x8_bf16 v[64:79], v[126:127], v[102:103], v[64:79]
    ds_read_b128 v[124:127], v3 offset:0
    ds_read_b32 v9, v8
    s_setprio 1
    v_exp_f32 v48, v48
    v_exp_f32 v49, v49
    v_exp_f32 v50, v50
    v_exp_f32 v51, v51
    s_setprio 2
    v_exp_f32 v52, v52
    v_exp_f32 v53, v53
    v_exp_f32 v54, v54
    v_exp_f32 v55, v55
    v_exp_f32 v56, v56
    v_exp_f32 v57, v57
    v_exp_f32 v58, v58
    v_exp_f32 v59, v59
    v_exp_f32 v60, v60
    v_exp_f32 v61, v61
    v_exp_f32 v62, v62
    v_exp_f32 v63, v63
    s_waitcnt lgkmcnt(0)
    v_cmp_gt_u32 vcc, s84, v9
    v_smfmac_f32_32x32x32_bf16 v[80:95], v[108:111], v[48:55], v5
    ds_read_b128 v[108:111], v4 offset:6912
    s_cbranch_vccnz slow_155
ret_156:
    v_mfma_f32_32x32x16_bf16 v[16:31], v[104:107], v[96:99], 0
    ds_read_b128 v[104:107], v2 offset:6912
    v_smfmac_f32_32x32x32_bf16 v[80:95], v[112:115], v[56:63], v5
    ds_read_b128 v[112:115], v4 offset:7552
    v_mfma_f32_32x32x8_bf16 v[16:31], v[124:125], v[100:101], v[16:31]
    s_bitcmp1_b32 s91, s84
    s_cbranch_scc0 nodma_157
    s_add_u32 m0, s86, 30720
    s_add_u32 s87, s87, 10240
    buffer_load_dwordx4 v10, s[56:59], s87 offen sc1 lds
    buffer_load_dword v11, s[56:59], s87 offen offset:1024 sc1 lds
dmaret_158:
    s_setprio 1
    v_exp_f32 v64, v64
    v_exp_f32 v65, v65
    v_exp_f32 v66, v66
    v_exp_f32 v67, v67
    s_setprio 2
    v_exp_f32 v68, v68
    v_exp_f32 v69, v69
    v_exp_f32 v70, v70
    v_exp_f32 v71, v71
    v_exp_f32 v72, v72
    v_exp_f32 v73, v73
    v_exp_f32 v74, v74
    v_exp_f32 v75, v75
    v_exp_f32 v76, v76
    v_exp_f32 v77, v77
    v_exp_f32 v78, v78
    v_exp_f32 v79, v79
    s_waitcnt vmcnt(2) lgkmcnt(0)
    v_smfmac_f32_32x32x32_bf16 v[80:95], v[108:111], v[64:71], v5
    ds_read_b128 v[108:111], v4 offset:10240
    ds_add_u32 v7, v6
    v_mfma_f32_32x32x16_bf16 v[32:47], v[104:107], v[96:99], 0
    ds_read_b128 v[104:107], v2 offset:10240
    v_smfmac_f32_32x32x32_bf16 v[80:95], v[112:115], v[72:79], v5
    ds_read_b128 v[112:115], v4 offset:10880
    v_mfma_f32_32x32x8_bf16 v[32:47], v[124:125], v[102:103], v[32:47]
    s_add_u32 s84, s84, 1
    s_setprio 1
    v_exp_f32 v16, v16
    v_exp_f32 v17, v17
    v_exp_f32 v18, v18
    v_exp_f32 v19, v19
    s_setprio 2
    v_exp_f32 v20, v20
    v_exp_f32 v21, v21
    v_exp_f32 v22, v22
    v_exp_f32 v23, v23
    v_exp_f32 v24, v24
    v_exp_f32 v25, v25
    v_exp_f32 v26, v26
    v_exp_f32 v27, v27
    v_exp_f32 v28, v28
    v_exp_f32 v29, v29
    v_exp_f32 v30, v30
    v_exp_f32 v31, v31
    s_waitcnt lgkmcnt(0)
    v_smfmac_f32_32x32x32_bf16 v[80:95], v[108:111], v[16:23], v5
    ds_read_b128 v[108:111], v4 offset:12544
    v_mfma_f32_32x32x16_bf16 v[48:63], v[104:107], v[96:99], 0
    ds_read_b128 v[104:107], v2 offset:12544
    v_smfmac_f32_32x32x32_bf16 v[80:95], v[112:115], v[24:31], v5
    ds_read_b128 v[112:115], v4 offset:13184
    v_mfma_f32_32x32x8_bf16 v[48:63], v[126:127], v[100:101], v[48:63]
    s_setprio 1
    v_exp_f32 v32, v32
    v_exp_f32 v33, v33
    v_exp_f32 v34, v34
    v_exp_f32 v35, v35
    s_setprio 2
    v_exp_f32 v36, v36
    v_exp_f32 v37, v37
    v_exp_f32 v38, v38
    v_exp_f32 v39, v39
    v_exp_f32 v40, v40
    v_exp_f32 v41, v41
    v_exp_f32 v42, v42
    v_exp_f32 v43, v43
    v_exp_f32 v44, v44
    v_exp_f32 v45, v45
    v_exp_f32 v46, v46
    v_exp_f32 v47, v47
    s_waitcnt lgkmcnt(0)
    v_smfmac_f32_32x32x32_bf16 v[80:95], v[108:111], v[32:39], v5
    ds_read_b128 v[108:111], v4 offset:14848
    v_mfma_f32_32x32x16_bf16 v[64:79], v[104:107], v[96:99], 0
    ds_read_b128 v[104:107], v2 offset:14848
    v_smfmac_f32_32x32x32_bf16 v[80:95], v[112:115], v[40:47], v5
    ds_read_b128 v[112:115], v4 offset:15488
    v_mfma_f32_32x32x8_bf16 v[64:79], v[126:127], v[102:103], v[64:79]
    ds_read_b128 v[124:127], v3 offset:10240
    ds_read_b32 v9, v8
    s_setprio 1
    v_exp_f32 v48, v48
    v_exp_f32 v49, v49
    v_exp_f32 v50, v50
    v_exp_f32 v51, v51
    s_setprio 2
    v_exp_f32 v52, v52
    v_exp_f32 v53, v53
    v_exp_f32 v54, v54
    v_exp_f32 v55, v55
    v_exp_f32 v56, v56
    v_exp_f32 v57, v57
    v_exp_f32 v58, v58
    v_exp_f32 v59, v59
    v_exp_f32 v60, v60
    v_exp_f32 v61, v61
    v_exp_f32 v62, v62
    v_exp_f32 v63, v63
    s_waitcnt lgkmcnt(0)
    v_cmp_gt_u32 vcc, s84, v9
    v_smfmac_f32_32x32x32_bf16 v[80:95], v[108:111], v[48:55], v5
    ds_read_b128 v[108:111], v4 offset:17152
    s_cbranch_vccnz slow_159
ret_160:
    v_mfma_f32_32x32x16_bf16 v[16:31], v[104:107], v[96:99], 0
    ds_read_b128 v[104:107], v2 offset:17152
    v_smfmac_f32_32x32x32_bf16 v[80:95], v[112:115], v[56:63], v5
    ds_read_b128 v[112:115], v4 offset:17792
    v_mfma_f32_32x32x8_bf16 v[16:31], v[124:125], v[100:101], v[16:31]
    s_bitcmp1_b32 s91, s84
    s_cbranch_scc0 nodma_161
    s_add_u32 m0, s86, 0
    s_add_u32 s87, s87, 10240
    buffer_load_dwordx4 v10, s[56:59], s87 offen sc1 lds
    buffer_load_dword v11, s[56:59], s87 offen offset:1024 sc1 lds
dmaret_162:
    s_setprio 1
    v_exp_f32 v64, v64
    v_exp_f32 v65, v65
    v_exp_f32 v66, v66
    v_exp_f32 v67, v67
    s_setprio 2
    v_exp_f32 v68, v68
    v_exp_f32 v69, v69
    v_exp_f32 v70, v70
    v_exp_f32 v71, v71
    v_exp_f32 v72, v72
    v_exp_f32 v73, v73
    v_exp_f32 v74, v74
    v_exp_f32 v75, v75
    v_exp_f32 v76, v76
    v_exp_f32 v77, v77
    v_exp_f32 v78, v78
    v_exp_f32 v79, v79
    s_waitcnt vmcnt(2) lgkmcnt(0)
    v_smfmac_f32_32x32x32_bf16 v[80:95], v[108:111], v[64:71], v5
    ds_read_b128 v[108:111], v4 offset:20480
    ds_add_u32 v7, v6
    v_mfma_f32_32x32x16_bf16 v[32:47], v[104:107], v[96:99], 0
    ds_read_b128 v[104:107], v2 offset:20480
    v_smfmac_f32_32x32x32_bf16 v[80:95], v[112:115], v[72:79], v5
    ds_read_b128 v[112:115], v4 offset:21120
    v_mfma_f32_32x32x8_bf16 v[32:47], v[124:125], v[102:103], v[32:47]
    s_add_u32 s84, s84, 1
    s_setprio 1
    v_exp_f32 v16, v16
    v_exp_f32 v17, v17
    v_exp_f32 v18, v18
    v_exp_f32 v19, v19
    s_setprio 2
    v_exp_f32 v20, v20
    v_exp_f32 v21, v21
    v_exp_f32 v22, v22
    v_exp_f32 v23, v23
    v_exp_f32 v24, v24
    v_exp_f32 v25, v25
    v_exp_f32 v26, v26
    v_exp_f32 v27, v27
    v_exp_f32 v28, v28
    v_exp_f32 v29, v29
    v_exp_f32 v30, v30
    v_exp_f32 v31, v31
    s_waitcnt lgkmcnt(0)
    v_smfmac_f32_32x32x32_bf16 v[80:95], v[108:111], v[16:23], v5
    ds_read_b128 v[108:111], v4 offset:22784
    v_mfma_f32_32x32x16_bf16 v[48:63], v[104:107], v[96:99], 0
    ds_read_b128 v[104:107], v2 offset:22784
    v_smfmac_f32_32x32x32_bf16 v[80:95], v[112:115], v[24:31], v5
    ds_read_b128 v[112:115], v4 offset:23424
    v_mfma_f32_32x32x8_bf16 v[48:63], v[126:127], v[100:101], v[48:63]
    s_setprio 1
    v_exp_f32 v32, v32
    v_exp_f32 v33, v33
    v_exp_f32 v34, v34
    v_exp_f32 v35, v35
    s_setprio 2
    v_exp_f32 v36, v36
    v_exp_f32 v37, v37
    v_exp_f32 v38, v38
    v_exp_f32 v39, v39
    v_exp_f32 v40, v40
    v_exp_f32 v41, v41
    v_exp_f32 v42, v42
    v_exp_f32 v43, v43
    v_exp_f32 v44, v44
    v_exp_f32 v45, v45
    v_exp_f32 v46, v46
    v_exp_f32 v47, v47
    s_waitcnt lgkmcnt(0)
    v_smfmac_f32_32x32x32_bf16 v[80:95], v[108:111], v[32:39], v5
    ds_read_b128 v[108:111], v4 offset:25088
    v_mfma_f32_32x32x16_bf16 v[64:79], v[104:107], v[96:99], 0
    ds_read_b128 v[104:107], v2 offset:25088
    v_smfmac_f32_32x32x32_bf16 v[80:95], v[112:115], v[40:47], v5
    ds_read_b128 v[112:115], v4 offset:25728
    v_mfma_f32_32x32x8_bf16 v[64:79], v[126:127], v[102:103], v[64:79]
    ds_read_b128 v[124:127], v3 offset:20480
    ds_read_b32 v9, v8
    s_setprio 1
    v_exp_f32 v48, v48
    v_exp_f32 v49, v49
    v_exp_f32 v50, v50
    v_exp_f32 v51, v51
    s_setprio 2
    v_exp_f32 v52, v52
    v_exp_f32 v53, v53
    v_exp_f32 v54, v54
    v_exp_f32 v55, v55
    v_exp_f32 v56, v56
    v_exp_f32 v57, v57
    v_exp_f32 v58, v58
    v_exp_f32 v59, v59
    v_exp_f32 v60, v60
    v_exp_f32 v61, v61
    v_exp_f32 v62, v62
    v_exp_f32 v63, v63
    s_waitcnt lgkmcnt(0)
    v_cmp_gt_u32 vcc, s84, v9
    v_smfmac_f32_32x32x32_bf16 v[80:95], v[108:111], v[48:55], v5
    ds_read_b128 v[108:111], v4 offset:27392
    s_cbranch_vccnz slow_163
ret_164:
    v_mfma_f32_32x32x16_bf16 v[16:31], v[104:107], v[96:99], 0
    ds_read_b128 v[104:107], v2 offset:27392
    v_smfmac_f32_32x32x32_bf16 v[80:95], v[112:115], v[56:63], v5
    ds_read_b128 v[112:115], v4 offset:28032
    v_mfma_f32_32x32x8_bf16 v[16:31], v[124:125], v[100:101], v[16:31]
    s_bitcmp1_b32 s91, s84
    s_cbranch_scc0 nodma_165
    s_add_u32 m0, s86, 10240
    s_add_u32 s87, s87, 10240
    buffer_load_dwordx4 v10, s[56:59], s87 offen sc1 lds
    buffer_load_dword v11, s[56:59], s87 offen offset:1024 sc1 lds
dmaret_166:
    s_setprio 1
    v_exp_f32 v64, v64
    v_exp_f32 v65, v65
    v_exp_f32 v66, v66
    v_exp_f32 v67, v67
    s_setprio 2
    v_exp_f32 v68, v68
    v_exp_f32 v69, v69
    v_exp_f32 v70, v70
    v_exp_f32 v71, v71
    v_exp_f32 v72, v72
    v_exp_f32 v73, v73
    v_exp_f32 v74, v74
    v_exp_f32 v75, v75
    v_exp_f32 v76, v76
    v_exp_f32 v77, v77
    v_exp_f32 v78, v78
    v_exp_f32 v79, v79
    s_waitcnt vmcnt(2) lgkmcnt(0)
    v_smfmac_f32_32x32x32_bf16 v[80:95], v[108:111], v[64:71], v5
    ds_read_b128 v[108:111], v4 offset:30720
    ds_add_u32 v7, v6
    v_mfma_f32_32x32x16_bf16 v[32:47], v[104:107], v[96:99], 0
    ds_read_b128 v[104:107], v2 offset:30720
    v_smfmac_f32_32x32x32_bf16 v[80:95], v[112:115], v[72:79], v5
    ds_read_b128 v[112:115], v4 offset:31360
    v_mfma_f32_32x32x8_bf16 v[32:47], v[124:125], v[102:103], v[32:47]
    s_add_u32 s84, s84, 1
    s_setprio 1
    v_exp_f32 v16, v16
    v_exp_f32 v17, v17
    v_exp_f32 v18, v18
    v_exp_f32 v19, v19
    s_setprio 2
    v_exp_f32 v20, v20
    v_exp_f32 v21, v21
    v_exp_f32 v22, v22
    v_exp_f32 v23, v23
    v_exp_f32 v24, v24
    v_exp_f32 v25, v25
    v_exp_f32 v26, v26
    v_exp_f32 v27, v27
    v_exp_f32 v28, v28
    v_exp_f32 v29, v29
    v_exp_f32 v30, v30
    v_exp_f32 v31, v31
    s_waitcnt lgkmcnt(0)
    v_smfmac_f32_32x32x32_bf16 v[80:95], v[108:111], v[16:23], v5
    ds_read_b128 v[108:111], v4 offset:33024
    v_mfma_f32_32x32x16_bf16 v[48:63], v[104:107], v[96:99], 0
    ds_read_b128 v[104:107], v2 offset:33024
    v_smfmac_f32_32x32x32_bf16 v[80:95], v[112:115], v[24:31], v5
    ds_read_b128 v[112:115], v4 offset:33664
    v_mfma_f32_32x32x8_bf16 v[48:63], v[126:127], v[100:101], v[48:63]
    s_setprio 1
    v_exp_f32 v32, v32
    v_exp_f32 v33, v33
    v_exp_f32 v34, v34
    v_exp_f32 v35, v35
    s_setprio 2
    v_exp_f32 v36, v36
    v_exp_f32 v37, v37
    v_exp_f32 v38, v38
    v_exp_f32 v39, v39
    v_exp_f32 v40, v40
    v_exp_f32 v41, v41
    v_exp_f32 v42, v42
    v_exp_f32 v43, v43
    v_exp_f32 v44, v44
    v_exp_f32 v45, v45
    v_exp_f32 v46, v46
    v_exp_f32 v47, v47
    s_waitcnt lgkmcnt(0)
    v_smfmac_f32_32x32x32_bf16 v[80:95], v[108:111], v[32:39], v5
    ds_read_b128 v[108:111], v4 offset:35328
    v_mfma_f32_32x32x16_bf16 v[64:79], v[104:107], v[96:99], 0
    ds_read_b128 v[104:107], v2 offset:35328
    v_smfmac_f32_32x32x32_bf16 v[80:95], v[112:115], v[40:47], v5
    ds_read_b128 v[112:115], v4 offset:35968
    v_mfma_f32_32x32x8_bf16 v[64:79], v[126:127], v[102:103], v[64:79]
    ds_read_b128 v[124:127], v3 offset:30720
    ds_read_b32 v9, v8
    s_setprio 1
    v_exp_f32 v48, v48
    v_exp_f32 v49, v49
    v_exp_f32 v50, v50
    v_exp_f32 v51, v51
    s_setprio 2
    v_exp_f32 v52, v52
    v_exp_f32 v53, v53
    v_exp_f32 v54, v54
    v_exp_f32 v55, v55
    v_exp_f32 v56, v56
    v_exp_f32 v57, v57
    v_exp_f32 v58, v58
    v_exp_f32 v59, v59
    v_exp_f32 v60, v60
    v_exp_f32 v61, v61
    v_exp_f32 v62, v62
    v_exp_f32 v63, v63
    s_waitcnt lgkmcnt(0)
    v_cmp_gt_u32 vcc, s84, v9
    v_smfmac_f32_32x32x32_bf16 v[80:95], v[108:111], v[48:55], v5
    ds_read_b128 v[108:111], v4 offset:37632
    s_cbranch_vccnz slow_167
ret_168:
    v_mfma_f32_32x32x16_bf16 v[16:31], v[104:107], v[96:99], 0
    ds_read_b128 v[104:107], v2 offset:37632
    v_smfmac_f32_32x32x32_bf16 v[80:95], v[112:115], v[56:63], v5
    ds_read_b128 v[112:115], v4 offset:38272
    v_mfma_f32_32x32x8_bf16 v[16:31], v[124:125], v[100:101], v[16:31]
    s_bitcmp1_b32 s91, s84
    s_cbranch_scc0 nodma_169
    s_add_u32 m0, s86, 20480
    s_add_u32 s87, s87, 10240
    buffer_load_dwordx4 v10, s[56:59], s87 offen sc1 lds
    buffer_load_dword v11, s[56:59], s87 offen offset:1024 sc1 lds
dmaret_170:
    s_cmp_lt_u32 s84, 16
    s_setprio 1
    v_exp_f32 v64, v64
    v_exp_f32 v65, v65
    v_exp_f32 v66, v66
    v_exp_f32 v67, v67
    s_setprio 2
    v_exp_f32 v68, v68
    v_exp_f32 v69, v69
    v_exp_f32 v70, v70
    v_exp_f32 v71, v71
    v_exp_f32 v72, v72
    v_exp_f32 v73, v73
    v_exp_f32 v74, v74
    v_exp_f32 v75, v75
    v_exp_f32 v76, v76
    v_exp_f32 v77, v77
    v_exp_f32 v78, v78
    v_exp_f32 v79, v79
    s_cbranch_scc1 L_aloop
    s_waitcnt lgkmcnt(0)
    v_smfmac_f32_32x32x32_bf16 v[80:95], v[108:111], v[64:71], v5
    ds_add_u32 v7, v6
    ds_read_b32 v123, v119 offset:4
    v_smfmac_f32_32x32x32_bf16 v[80:95], v[112:115], v[72:79], v5
    s_nop 11
    v_mov_b32 v122, v90
    s_nop 1
    v_permlane32_swap_b32 v90, v122
    v_rcp_f32 v122, v90
    s_waitcnt lgkmcnt(0)
    v_mul_f32 v122, v122, v123
    v_mul_f32 v80, v80, v122
    v_mul_f32 v81, v81, v122
    v_cvt_pk_bf16_f32 v16, v80, v81
    v_mul_f32 v82, v82, v122
    v_mul_f32 v83, v83, v122
    v_cvt_pk_bf16_f32 v17, v82, v83
    v_mul_f32 v84, v84, v122
    v_mul_f32 v85, v85, v122
    v_cvt_pk_bf16_f32 v18, v84, v85
    v_mul_f32 v86, v86, v122
    v_mul_f32 v87, v87, v122
    v_cvt_pk_bf16_f32 v19, v86, v87
    buffer_store_dwordx4 v[16:19], v140, s[52:55], s88 offen sc1
    v_mul_f32 v88, v88, v122
    v_mul_f32 v89, v89, v122
    v_cvt_pk_bf16_f32 v20, v88, v89
    buffer_store_dword v20, v141, s[52:55], s89 offen sc1
    s_setprio 0
    v_add_u32 v1, 163584, v146
    ds_read_b64 v[146:147], v1
    v_add_u32 v1, 163584, v138
    ds_read_b64 v[138:139], v1
    v_add_u32 v1, 163584, v142
    ds_read_b64 v[142:143], v1
    s_mul_i32 s8, s5, 2304
    v_add_u32 v27, s8, v10
    s_lshl_b32 s11, s5, 6
    s_add_u32 s11, s11, 163072
    v_add_u32 v1, 0, v0
    v_mul_u32_u24 v21, 57, v1
    v_lshrrev_b32 v21, 10, v21
    v_lshl_add_u32 v40, v21, 3, s11
    ds_read_b32 v40, v40
    v_add_u32 v1, 64, v0
    v_mul_u32_u24 v21, 57, v1
    v_lshrrev_b32 v21, 10, v21
    v_lshl_add_u32 v41, v21, 3, s11
    ds_read_b32 v41, v41
    v_add_u32 v1, 128, v0
    v_mul_u32_u24 v21, 57, v1
    v_lshrrev_b32 v21, 10, v21
    v_lshl_add_u32 v42, v21, 3, s11
    ds_read_b32 v42, v42
    s_waitcnt lgkmcnt(3)
    v_lshlrev_b32 v1, 16, v132
    v_lshlrev_b32 v21, 16, v146
    v_and_b32 v132, 0xffff0000, v132
    v_and_b32 v146, 0xffff0000, v146
    v_mul_f32 v1, v1, v21
    v_mul_f32 v132, v132, v146
    v_cvt_pk_bf16_f32 v1, v1, v132
    v_lshlrev_b32 v44, 16, v1
    v_and_b32 v45, 0xffff0000, v1
    v_lshlrev_b32 v1, 16, v133
    v_lshlrev_b32 v21, 16, v147
    v_and_b32 v133, 0xffff0000, v133
    v_and_b32 v147, 0xffff0000, v147
    v_mul_f32 v1, v1, v21
    v_mul_f32 v133, v133, v147
    v_cvt_pk_bf16_f32 v1, v1, v133
    v_lshlrev_b32 v46, 16, v1
    v_and_b32 v47, 0xffff0000, v1
    v_lshlrev_b32 v1, 16, v134
    v_lshlrev_b32 v21, 16, v138
    v_and_b32 v134, 0xffff0000, v134
    v_and_b32 v138, 0xffff0000, v138
    v_mul_f32 v1, v1, v21
    v_mul_f32 v134, v134, v138
    v_cvt_pk_bf16_f32 v1, v1, v134
    v_lshlrev_b32 v48, 16, v1
    v_and_b32 v49, 0xffff0000, v1
    v_lshlrev_b32 v1, 16, v135
    v_lshlrev_b32 v21, 16, v139
    v_and_b32 v135, 0xffff0000, v135
    v_and_b32 v139, 0xffff0000, v139
    v_mul_f32 v1, v1, v21
    v_mul_f32 v135, v135, v139
    v_cvt_pk_bf16_f32 v1, v1, v135
    v_lshlrev_b32 v50, 16, v1
    v_and_b32 v51, 0xffff0000, v1
    v_lshlrev_b32 v1, 16, v136
    v_lshlrev_b32 v21, 16, v142
    v_and_b32 v136, 0xffff0000, v136
    v_and_b32 v142, 0xffff0000, v142
    v_mul_f32 v1, v1, v21
    v_mul_f32 v136, v136, v142
    v_cvt_pk_bf16_f32 v1, v1, v136
    v_lshlrev_b32 v52, 16, v1
    v_and_b32 v53, 0xffff0000, v1
    v_lshlrev_b32 v1, 16, v137
    v_lshlrev_b32 v21, 16, v143
    v_and_b32 v137, 0xffff0000, v137
    v_and_b32 v143, 0xffff0000, v143
    v_mul_f32 v1, v1, v21
    v_mul_f32 v137, v137, v143
    v_cvt_pk_bf16_f32 v1, v1, v137
    v_lshlrev_b32 v54, 16, v1
    v_and_b32 v55, 0xffff0000, v1
    s_waitcnt lgkmcnt(0)
    v_mul_f32 v44, v44, v40
    v_mul_f32 v45, v45, v40
    v_mul_f32 v46, v46, v40
    v_mul_f32 v47, v47, v40
    v_add_f32 v40, v40, v40
    v_max_f32 v40, 562036736, v40
    v_mul_f32 v48, v48, v41
    v_mul_f32 v49, v49, v41
    v_mul_f32 v50, v50, v41
    v_mul_f32 v51, v51, v41
    v_add_f32 v41, v41, v41
    v_max_f32 v41, 562036736, v41
    v_mul_f32 v52, v52, v42
    v_mul_f32 v53, v53, v42
    v_mul_f32 v54, v54, v42
    v_mul_f32 v55, v55, v42
    v_add_f32 v42, v42, v42
    v_max_f32 v42, 562036736, v42
    s_barrier
    ds_read_b128 v[56:59], v27 offset:0
    ds_read_b128 v[60:63], v27 offset:18432
    ds_read_b128 v[64:67], v27 offset:36864
    ds_read_b128 v[68:71], v27 offset:55296
    ds_read_b128 v[72:75], v27 offset:1024
    ds_read_b128 v[76:79], v27 offset:19456
    ds_read_b128 v[80:83], v27 offset:37888
    ds_read_b128 v[84:87], v27 offset:56320
    ds_read_b128 v[88:91], v27 offset:2048
    ds_read_b128 v[92:95], v27 offset:20480
    ds_read_b128 v[96:99], v27 offset:38912
    ds_read_b128 v[100:103], v27 offset:57344
    s_waitcnt lgkmcnt(8)
    v_add_f32 v56, v56, v60
    v_add_f32 v57, v57, v61
    v_add_f32 v58, v58, v62
    v_add_f32 v59, v59, v63
    v_add_f32 v64, v64, v68
    v_add_f32 v65, v65, v69
    v_add_f32 v66, v66, v70
    v_add_f32 v67, v67, v71
    v_add_f32 v56, v56, v64
    v_add_f32 v57, v57, v65
    v_add_f32 v58, v58, v66
    v_add_f32 v59, v59, v67
    v_fma_f32 v56, v56, v40, v44
    v_fma_f32 v57, v57, v40, v45
    v_fma_f32 v58, v58, v40, v46
    v_fma_f32 v59, v59, v40, v47
    buffer_store_dwordx4 v[56:59], v164, s[64:67], s90 offen
    s_waitcnt lgkmcnt(4)
    v_add_f32 v72, v72, v76
    v_add_f32 v73, v73, v77
    v_add_f32 v74, v74, v78
    v_add_f32 v75, v75, v79
    v_add_f32 v80, v80, v84
    v_add_f32 v81, v81, v85
    v_add_f32 v82, v82, v86
    v_add_f32 v83, v83, v87
    v_add_f32 v72, v72, v80
    v_add_f32 v73, v73, v81
    v_add_f32 v74, v74, v82
    v_add_f32 v75, v75, v83
    v_fma_f32 v72, v72, v41, v48
    v_fma_f32 v73, v73, v41, v49
    v_fma_f32 v74, v74, v41, v50
    v_fma_f32 v75, v75, v41, v51
    buffer_store_dwordx4 v[72:75], v165, s[64:67], s90 offen
    s_waitcnt lgkmcnt(0)
    v_add_f32 v88, v88, v92
    v_add_f32 v89, v89, v93
    v_add_f32 v90, v90, v94
    v_add_f32 v91, v91, v95
    v_add_f32 v96, v96, v100
    v_add_f32 v97, v97, v101
    v_add_f32 v98, v98, v102
    v_add_f32 v99, v99, v103
    v_add_f32 v88, v88, v96
    v_add_f32 v89, v89, v97
    v_add_f32 v90, v90, v98
    v_add_f32 v91, v91, v99
    v_fma_f32 v88, v88, v42, v52
    v_fma_f32 v89, v89, v42, v53
    v_fma_f32 v90, v90, v42, v54
    v_fma_f32 v91, v91, v42, v55
    buffer_store_dwordx4 v[88:91], v166, s[64:67], s90 offen
L_end:
    s_endpgm
nodma_157:
    s_waitcnt vmcnt(0)
    s_branch dmaret_158
nodma_161:
    s_waitcnt vmcnt(0)
    s_branch dmaret_162
nodma_165:
    s_waitcnt vmcnt(0)
    s_branch dmaret_166
nodma_169:
    s_waitcnt vmcnt(0)
    s_branch dmaret_170
slow_155:
    s_sleep 4
    s_mov_b32 s15, 0
lw_172:
    ds_read_b32 v9, v8 offset:0
    s_waitcnt lgkmcnt(0)
    v_cmp_gt_u32 vcc, s84, v9
    s_nop 0
    s_cbranch_vccz lwd_173
    s_sleep 4
    s_add_u32 s15, s15, 1
    s_cmp_lt_u32 s15, 0x100000
    s_cbranch_scc1 lw_172
lwd_173:
    s_branch ret_156
slow_159:
    s_sleep 4
    s_mov_b32 s15, 0
lw_174:
    ds_read_b32 v9, v8 offset:0
    s_waitcnt lgkmcnt(0)
    v_cmp_gt_u32 vcc, s84, v9
    s_nop 0
    s_cbranch_vccz lwd_175
    s_sleep 4
    s_add_u32 s15, s15, 1
    s_cmp_lt_u32 s15, 0x100000
    s_cbranch_scc1 lw_174
lwd_175:
    s_branch ret_160
slow_163:
    s_sleep 4
    s_mov_b32 s15, 0
lw_176:
    ds_read_b32 v9, v8 offset:0
    s_waitcnt lgkmcnt(0)
    v_cmp_gt_u32 vcc, s84, v9
    s_nop 0
    s_cbranch_vccz lwd_177
    s_sleep 4
    s_add_u32 s15, s15, 1
    s_cmp_lt_u32 s15, 0x100000
    s_cbranch_scc1 lw_176
lwd_177:
    s_branch ret_164
slow_167:
    s_sleep 4
    s_mov_b32 s15, 0
lw_178:
    ds_read_b32 v9, v8 offset:0
    s_waitcnt lgkmcnt(0)
    v_cmp_gt_u32 vcc, s84, v9
    s_nop 0
    s_cbranch_vccz lwd_179
    s_sleep 4
    s_add_u32 s15, s15, 1
    s_cmp_lt_u32 s15, 0x100000
    s_cbranch_scc1 lw_178
lwd_179:
    s_branch ret_168
L_fallback:
    v_mov_b32 v101, 0
    v_mov_b32 v123, 0xff7fffff
    v_lshl_add_u32 v156, v116, 30, v10
    v_mov_b32 v155, 0
    s_mov_b32 s10, 75776
L_fb_loop:
    s_add_u32 s11, s10, 4294961664
    s_add_u32 s12, s10, 4294966272
    buffer_load_dwordx4 v[128:131], v10, s[52:55], s11 offen sc1
    buffer_load_dword v154, v156, s[52:55], s12 offen sc1
    s_waitcnt vmcnt(0)
    v_mfma_f32_32x32x16_bf16 v[32:47], v[128:131], v[96:99], 0
    v_mfma_f32_32x32x8_bf16 v[32:47], v[154:155], v[100:101], v[32:47]
    s_nop 11
    v_max3_f32 v123, v123, v32, v33
    v_max3_f32 v123, v123, v34, v35
    v_max3_f32 v123, v123, v36, v37
    v_max3_f32 v123, v123, v38, v39
    v_max3_f32 v123, v123, v40, v41
    v_max3_f32 v123, v123, v42, v43
    v_max3_f32 v123, v123, v44, v45
    v_max3_f32 v123, v123, v46, v47
    s_add_u32 s11, s10, 4294963968
    s_add_u32 s12, s10, 4294966276
    buffer_load_dwordx4 v[128:131], v10, s[52:55], s11 offen sc1
    buffer_load_dword v154, v156, s[52:55], s12 offen sc1
    s_waitcnt vmcnt(0)
    v_mfma_f32_32x32x16_bf16 v[32:47], v[128:131], v[96:99], 0
    v_mfma_f32_32x32x8_bf16 v[32:47], v[154:155], v[100:101], v[32:47]
    s_nop 11
    v_max3_f32 v123, v123, v32, v33
    v_max3_f32 v123, v123, v34, v35
    v_max3_f32 v123, v123, v36, v37
    v_max3_f32 v123, v123, v38, v39
    v_max3_f32 v123, v123, v40, v41
    v_max3_f32 v123, v123, v42, v43
    v_max3_f32 v123, v123, v44, v45
    v_max3_f32 v123, v123, v46, v47
    s_add_u32 s11, s10, 0
    s_add_u32 s12, s10, 4294966280
    buffer_load_dwordx4 v[128:131], v10, s[52:55], s11 offen sc1
    buffer_load_dword v154, v156, s[52:55], s12 offen sc1
    s_waitcnt vmcnt(0)
    v_mfma_f32_32x32x16_bf16 v[32:47], v[128:131], v[96:99], 0
    v_mfma_f32_32x32x8_bf16 v[32:47], v[154:155], v[100:101], v[32:47]
    s_nop 11
    v_max3_f32 v123, v123, v32, v33
    v_max3_f32 v123, v123, v34, v35
    v_max3_f32 v123, v123, v36, v37
    v_max3_f32 v123, v123, v38, v39
    v_max3_f32 v123, v123, v40, v41
    v_max3_f32 v123, v123, v42, v43
    v_max3_f32 v123, v123, v44, v45
    v_max3_f32 v123, v123, v46, v47
    s_add_u32 s11, s10, 2304
    s_add_u32 s12, s10, 4294966284
    buffer_load_dwordx4 v[128:131], v10, s[52:55], s11 offen sc1
    buffer_load_dword v154, v156, s[52:55], s12 offen sc1
    s_waitcnt vmcnt(0)
    v_mfma_f32_32x32x16_bf16 v[32:47], v[128:131], v[96:99], 0
    v_mfma_f32_32x32x8_bf16 v[32:47], v[154:155], v[100:101], v[32:47]
    s_nop 11
    v_max3_f32 v123, v123, v32, v33
    v_max3_f32 v123, v123, v34, v35
    v_max3_f32 v123, v123, v36, v37
    v_max3_f32 v123, v123, v38, v39
    v_max3_f32 v123, v123, v40, v41
    v_max3_f32 v123, v123, v42, v43
    v_max3_f32 v123, v123, v44, v45
    v_max3_f32 v123, v123, v46, v47
    s_add_u32 s10, s10, 10240
    s_cmp_lt_u32 s10, 239616
    s_cbranch_scc1 L_fb_loop
    v_mov_b32 v129, v123
    s_nop 1
    v_permlane32_swap_b32 v129, v123
    v_max_f32 v123, v129, v123
    v_xor_b32 v123, 0x80000000, v123
    v_and_b32 v128, 0xffff0000, v123
    v_sub_f32 v123, v123, v128
    v_and_b32 v129, 0xffff0000, v123
    v_sub_f32 v123, v123, v129
    v_lshrrev_b32 v128, 16, v128
    v_or_b32 v128, v128, v129
    v_lshrrev_b32 v123, 16, v123
    v_cndmask_b32 v101, 0, v128, s[8:9]
    v_cndmask_b32 v102, 0, v128, s[8:9]
    v_cndmask_b32 v100, v100, v123, s[8:9]
    v_mov_b32 v103, v100
    s_nop 1
    s_branch L_have_max
.section .rodata,"a"
.p2align 6
.amdhsa_kernel gated_mix__ssm_conv_s5__grouped_kv_mqa__prompt_kernel
  .amdhsa_next_free_vgpr 168
  .amdhsa_next_free_sgpr 102
  .amdhsa_accum_offset 168
  .amdhsa_group_segment_fixed_size 0
  .amdhsa_kernarg_size 144
  .amdhsa_user_sgpr_count 2
  .amdhsa_user_sgpr_kernarg_segment_ptr 1
  .amdhsa_system_sgpr_workgroup_id_x 1
.end_amdhsa_kernel
```
